```python
import torch

def _softmax(x, axis=-1):
    return torch.softmax(x, dim=axis)
def _gelu(x):
    return torch.nn.functional.gelu(x, approximate="tanh")
def _silu(x):
    return torch.nn.functional.silu(x)
def _sigmoid(x):
    return torch.sigmoid(x)
def _layernorm(x, axis=-1, eps=1e-5):
    m = x.mean(dim=axis, keepdim=True)
    v = x.var(dim=axis, keepdim=True, unbiased=False)
    return (x - m) / torch.sqrt(v + eps)
def _scatter_add(tgt, idx, src, axis=0):
    return tgt.clone().index_add_(axis, idx, src)
def _segment_sum(src, seg, n):
    out = torch.zeros((n,) + src.shape[1:], dtype=src.dtype)
    return out.index_add_(0, seg, src)
def _pad(x, pw):
    flat = tuple(v for pair in reversed(pw) for v in pair)
    return torch.nn.functional.pad(x, flat)

kernel_name = 'gated_mix__linear_attn_block__sliding_block__prompt'

def setup_inputs():

    _w = (lambda a: (lambda t: t.to(torch.bfloat16) if t.is_floating_point() else t)(torch.as_tensor(a)))
    def _A_setup():
        B, S, D = 1, 2048, 448
        return {
            "x": _w((lambda *s: torch.randn(*s, dtype=torch.bfloat16) * 0.05)(B, S, D)),
            "wqkv": _w((lambda *s: torch.randn(*s, dtype=torch.bfloat16) * 1.6)(D, 3 * D)),
            "wo": _w((lambda *s: torch.randn(*s, dtype=torch.bfloat16) * 0.8)(D, D)),
        }
    _A_in = _A_setup()

    def _B_setup():
        B, S, D = 1, 2048, 448
        return {
            "x": _w((lambda *s: torch.randn(*s, dtype=torch.bfloat16) * 0.05)(B, S, D)),
            "wqkv": _w((lambda *s: torch.randn(*s, dtype=torch.bfloat16) * 1.6)(D, 3 * D)),
            "wo": _w((lambda *s: torch.randn(*s, dtype=torch.bfloat16) * 0.05)(D, D)),
        }
    _B_in = _B_setup()

    return {
        "A_x": _A_in["x"],
        "A_wqkv": _A_in["wqkv"],
        "A_wo": _A_in["wo"],
        "B_x": _B_in["x"],
        "B_wqkv": _B_in["wqkv"],
        "B_wo": _B_in["wo"],
        "gate_w": _w((lambda *s: torch.randn(*s, dtype=torch.bfloat16) * 0.05)(448) * 16.0),
    }

def reference(A_x, A_wqkv, A_wo, B_x, B_wqkv, B_wo, gate_w):
    def _A_ref(x, wqkv, wo):
        B, S, D = x.shape
        H = 16; Dh = D // H
        qkv = (lambda x, *d: x.permute(*d))((x @ wqkv).reshape(B, S, 3, H, Dh), 2, 0, 3, 1, 4)
        q, k, v = qkv[0], qkv[1], qkv[2]
        phi = lambda t: torch.where(t > 0, t + 1, torch.exp(t)) + 1e-6
        pq, pk = phi(q), phi(k)
        kv = torch.einsum("bhsd,bhse->bhde", pk, v)
        z = torch.einsum("bhsd->bhd", pk)
        num = torch.einsum("bhqd,bhde->bhqe", pq, kv)
        den = torch.einsum("bhqd,bhd->bhq", pq, z)[..., None] + 1e-6
        o = num / den
        return (lambda x, *d: x.permute(*d))(o, 0, 2, 1, 3).reshape(B, S, D) @ wo

    def _B_ref(x, wqkv, wo):
        B, S, D = x.shape
        H = 16; Dh = D // H; W = 256
        qkv = (lambda x, *d: x.permute(*d))((x @ wqkv).reshape(B, S, 3, H, Dh), 2, 0, 3, 1, 4)
        q, k, v = qkv[0], qkv[1], qkv[2]
        scores = torch.einsum("bhqd,bhkd->bhqk", q, k) * (Dh ** -0.5)
        idx = torch.arange(S)
        mask = (idx[:, None] - idx[None, :] >= 0) & (idx[:, None] - idx[None, :] < W)
        scores = torch.where(mask[None, None], scores, -1e9)
        p = _softmax(scores, axis=-1)
        o = torch.einsum("bhqk,bhkd->bhqd", p, v)
        return (lambda x, *d: x.permute(*d))(o, 0, 2, 1, 3).reshape(B, S, D) @ wo

    x = A_x
    g = _sigmoid((x * gate_w).sum(-1, keepdims=True))
    a = _A_ref(x, A_wqkv, A_wo)
    b = _B_ref(x, B_wqkv, B_wo)
    return g * a + (1 - g) * b
```

```asm
; @launch grid=(256,1,1) block=(512,1,1) lds=163840
.amdgcn_target "amdgcn-amd-amdhsa--gfx950"
.text
.globl gated_mix__linear_attn_block__sliding_block__prompt_kernel
.p2align 8
.type gated_mix__linear_attn_block__sliding_block__prompt_kernel,@function
gated_mix__linear_attn_block__sliding_block__prompt_kernel:
    s_cmp_ge_u32 s2, 256
    s_cbranch_scc1 L_end
    s_memrealtime s[80:81]
    s_load_dwordx16 s[4:19], s[0:1], 0
    s_load_dwordx4 s[20:23], s[0:1], 64
    v_lshrrev_b32 v2, 6, v0
    v_and_b32 v0, 63, v0
    s_and_b32 s52, s2, 7
    v_readfirstlane_b32 s54, v2
    s_lshr_b32 s53, s2, 3
    s_lshr_b32 s55, s53, 4
    s_and_b32 s65, s52, 1
    s_lshl_b32 s65, s65, 3
    s_and_b32 s66, s53, 7
    s_add_u32 s56, s65, s66
    s_and_b32 s65, s52, 6
    s_bfe_u32 s66, s53, 0x10003
    s_add_u32 s57, s65, s66
    v_lshlrev_b32 v1, 4, v0
    s_cmp_ge_u32 s54, 4
    s_cbranch_scc1 L_loader
    s_cmp_eq_u32 s54, 3
    s_cbranch_scc0 L_nocode
    s_cmp_lt_u32 s53, 3
    s_cbranch_scc0 L_nocode
    s_getpc_b64 s[68:69]
L_pc:
    s_lshl_b32 s65, s53, 13
    v_lshlrev_b32 v11, 7, v0
    v_add_u32 v11, s65, v11
    v_min_u32 v11, L_codeend-L_pc, v11
    global_load_dword v63, v11, s[68:69]
L_nocode:
    v_and_b32 v11, 31, v0
    v_lshrrev_b32 v12, 5, v0
    v_bfe_u32 v13, v0, 1, 3
    v_xor_b32 v13, v13, v12
    s_lshr_b32 s65, s54, 1
    s_lshl_b32 s65, s65, 13
    v_lshlrev_b32 v14, 7, v11
    v_add_u32 v14, s65, v14
    v_xor_b32 v15, 0, v13
    v_lshl_add_u32 v5, v15, 4, v14
    v_xor_b32 v15, 2, v13
    v_lshl_add_u32 v6, v15, 4, v14
    v_xor_b32 v15, 4, v13
    v_lshl_add_u32 v7, v15, 4, v14
    v_xor_b32 v15, 6, v13
    v_lshl_add_u32 v8, v15, 4, v14
    v_mov_b32 v64, 0
    v_mov_b32 v65, 0
    v_mov_b32 v66, 0
    v_mov_b32 v67, 0
    v_mov_b32 v68, 0
    v_mov_b32 v69, 0
    v_mov_b32 v70, 0
    v_mov_b32 v71, 0
    v_mov_b32 v72, 0
    v_mov_b32 v73, 0
    v_mov_b32 v74, 0
    v_mov_b32 v75, 0
    v_mov_b32 v76, 0
    v_mov_b32 v77, 0
    v_mov_b32 v78, 0
    v_mov_b32 v79, 0
    v_mov_b32 v80, 0
    v_mov_b32 v81, 0
    v_mov_b32 v82, 0
    v_mov_b32 v83, 0
    v_mov_b32 v84, 0
    v_mov_b32 v85, 0
    v_mov_b32 v86, 0
    v_mov_b32 v87, 0
    v_mov_b32 v88, 0
    v_mov_b32 v89, 0
    v_mov_b32 v90, 0
    v_mov_b32 v91, 0
    v_mov_b32 v92, 0
    v_mov_b32 v93, 0
    v_mov_b32 v94, 0
    v_mov_b32 v95, 0
    v_mov_b32 v96, 0
    v_mov_b32 v97, 0
    v_mov_b32 v98, 0
    v_mov_b32 v99, 0
    v_mov_b32 v100, 0
    v_mov_b32 v101, 0
    v_mov_b32 v102, 0
    v_mov_b32 v103, 0
    v_mov_b32 v104, 0
    v_mov_b32 v105, 0
    v_mov_b32 v106, 0
    v_mov_b32 v107, 0
    v_mov_b32 v108, 0
    v_mov_b32 v109, 0
    v_mov_b32 v110, 0
    v_mov_b32 v111, 0
    v_mov_b32 v112, 0
    v_mov_b32 v113, 0
    v_mov_b32 v114, 0
    v_mov_b32 v115, 0
    v_mov_b32 v116, 0
    v_mov_b32 v117, 0
    v_mov_b32 v118, 0
    v_mov_b32 v119, 0
    v_mov_b32 v120, 0
    v_mov_b32 v121, 0
    v_mov_b32 v122, 0
    v_mov_b32 v123, 0
    v_mov_b32 v124, 0
    v_mov_b32 v125, 0
    v_mov_b32 v126, 0
    v_mov_b32 v127, 0
    v_mov_b32 v128, 0
    v_mov_b32 v129, 0
    v_mov_b32 v130, 0
    v_mov_b32 v131, 0
    v_mov_b32 v132, 0
    v_mov_b32 v133, 0
    v_mov_b32 v134, 0
    v_mov_b32 v135, 0
    v_mov_b32 v136, 0
    v_mov_b32 v137, 0
    v_mov_b32 v138, 0
    v_mov_b32 v139, 0
    v_mov_b32 v140, 0
    v_mov_b32 v141, 0
    v_mov_b32 v142, 0
    v_mov_b32 v143, 0
    v_mov_b32 v144, 0
    v_mov_b32 v145, 0
    v_mov_b32 v146, 0
    v_mov_b32 v147, 0
    v_mov_b32 v148, 0
    v_mov_b32 v149, 0
    v_mov_b32 v150, 0
    v_mov_b32 v151, 0
    v_mov_b32 v152, 0
    v_mov_b32 v153, 0
    v_mov_b32 v154, 0
    v_mov_b32 v155, 0
    v_mov_b32 v156, 0
    v_mov_b32 v157, 0
    v_mov_b32 v158, 0
    v_mov_b32 v159, 0
    s_waitcnt lgkmcnt(0)
    s_mov_b32 s24, s4
    s_mov_b32 s25, s5
    s_mov_b32 s26, 0x1c0000
    s_mov_b32 s27, 0x20000
    s_mov_b32 s32, s22
    s_mov_b32 s33, s23
    s_mov_b32 s34, 0x1000000
    s_mov_b32 s35, 0x20000
    s_mov_b32 s44, s20
    s_mov_b32 s45, s21
    s_mov_b32 s46, 0x100
    s_mov_b32 s47, 0x20000
    s_mov_b32 s40, s18
    s_mov_b32 s41, s19
    s_mov_b32 s42, 0x1c0000
    s_mov_b32 s43, 0x20000
    s_mov_b32 s61, 0
    s_cmp_eq_u32 s55, 1
    s_cbranch_scc1 L1_B
    v_mov_b32 v10, 0
    s_or_b32 s65, s2, s54
    s_cmp_eq_u32 s65, 0
    s_cbranch_scc0 L_nononce
    s_or_b32 s80, s80, 1
    v_mov_b32 v11, s80
    buffer_store_dword v11, v10, s[44:47], 0 offen sc1
L_nononce:
    s_lshr_b32 s66, s54, 1
    s_add_u32 s65, s56, s66
    s_cmp_eq_u32 s65, 0
    s_cbranch_scc0 L_nozero
    s_lshl_b32 s65, s57, 1
    s_add_u32 s65, s65, s54
    s_lshl_b32 s65, s65, 12
    s_add_u32 s65, s65, 0xc00000
    v_mov_b32 v12, 0
    v_mov_b32 v13, 0
    v_mov_b32 v14, 0
    v_mov_b32 v15, 0
    buffer_store_dwordx4 v[12:15], v1, s[32:35], s65 offen offset:0 sc1
    buffer_store_dwordx4 v[12:15], v1, s[32:35], s65 offen offset:1024 sc1
    buffer_store_dwordx4 v[12:15], v1, s[32:35], s65 offen offset:2048 sc1
    buffer_store_dwordx4 v[12:15], v1, s[32:35], s65 offen offset:3072 sc1
    s_waitcnt vmcnt(0)
    s_nop 0
L_nozero:
    v_lshrrev_b32 v12, 5, v0
    v_bfe_u32 v13, v0, 2, 2
    v_lshl_add_u32 v14, v12, 3, v13
    v_lshlrev_b32 v14, 7, v14
    v_bfe_u32 v15, v0, 4, 1
    v_lshlrev_b32 v15, 5, v15
    v_and_b32 v16, 3, v0
    v_lshl_add_u32 v15, v16, 3, v15
    s_and_b32 s65, s54, 1
    s_mul_i32 s65, s65, 56
    v_add_u32 v15, s65, v15
    v_bfe_u32 v16, v0, 3, 1
    v_lshlrev_b32 v16, 6, v16
    v_xor_b32 v15, v15, v16
    v_add_u32 v14, v14, v15
    v_add_u32 v52, 16384, v14
    s_barrier
    s_add_u32 s65, s56, s54
    s_cmp_eq_u32 s65, 0
    s_cbranch_scc0 L_nofz
    s_lshl_b32 s65, s57, 2
    s_add_u32 s65, s65, 4
    v_mov_b32 v10, 0
    v_mov_b32 v11, 1
    s_mov_b64 exec, 1
    buffer_store_dword v11, v10, s[44:47], s65 offen sc1
    s_mov_b64 exec, -1
L_nofz:
    ds_read_b128 v[12:15], v5 offset:0
    ds_read_b128 v[16:19], v5 offset:4096
    ds_read_b64_tr_b16 v[28:29], v52 offset:0
    ds_read_b64_tr_b16 v[30:31], v52 offset:512
    ds_read_b64_tr_b16 v[32:33], v52 offset:8192
    ds_read_b64_tr_b16 v[34:35], v52 offset:8704
    ds_read_b64_tr_b16 v[36:37], v52 offset:16384
    ds_read_b64_tr_b16 v[38:39], v52 offset:16896
L1_loopA:
    s_waitcnt lgkmcnt(0)
    v_mfma_f32_32x32x16_bf16 v[64:79], v[28:31], v[12:15], v[64:79]
    ds_read_b128 v[20:23], v6 offset:0
    ds_read_b128 v[24:27], v6 offset:4096
    v_mfma_f32_32x32x16_bf16 v[80:95], v[12:15], v[32:35], v[80:95]
    ds_read_b64_tr_b16 v[40:41], v52 offset:2048
    ds_read_b64_tr_b16 v[42:43], v52 offset:2560
    v_mfma_f32_32x32x16_bf16 v[96:111], v[12:15], v[36:39], v[96:111]
    ds_read_b64_tr_b16 v[44:45], v52 offset:10240
    ds_read_b64_tr_b16 v[46:47], v52 offset:10752
    v_mfma_f32_32x32x16_bf16 v[112:127], v[28:31], v[16:19], v[112:127]
    ds_read_b64_tr_b16 v[48:49], v52 offset:18432
    ds_read_b64_tr_b16 v[50:51], v52 offset:18944
    v_mfma_f32_32x32x16_bf16 v[128:143], v[16:19], v[32:35], v[128:143]
    v_mfma_f32_32x32x16_bf16 v[144:159], v[16:19], v[36:39], v[144:159]
    s_waitcnt lgkmcnt(0)
    v_mfma_f32_32x32x16_bf16 v[64:79], v[40:43], v[20:23], v[64:79]
    ds_read_b128 v[12:15], v7 offset:0
    ds_read_b128 v[16:19], v7 offset:4096
    v_mfma_f32_32x32x16_bf16 v[80:95], v[20:23], v[44:47], v[80:95]
    ds_read_b64_tr_b16 v[28:29], v52 offset:4096
    ds_read_b64_tr_b16 v[30:31], v52 offset:4608
    v_mfma_f32_32x32x16_bf16 v[96:111], v[20:23], v[48:51], v[96:111]
    ds_read_b64_tr_b16 v[32:33], v52 offset:12288
    ds_read_b64_tr_b16 v[34:35], v52 offset:12800
    v_mfma_f32_32x32x16_bf16 v[112:127], v[40:43], v[24:27], v[112:127]
    ds_read_b64_tr_b16 v[36:37], v52 offset:20480
    ds_read_b64_tr_b16 v[38:39], v52 offset:20992
    v_mfma_f32_32x32x16_bf16 v[128:143], v[24:27], v[44:47], v[128:143]
    v_mfma_f32_32x32x16_bf16 v[144:159], v[24:27], v[48:51], v[144:159]
    s_waitcnt lgkmcnt(0)
    v_mfma_f32_32x32x16_bf16 v[64:79], v[28:31], v[12:15], v[64:79]
    ds_read_b128 v[20:23], v8 offset:0
    ds_read_b128 v[24:27], v8 offset:4096
    v_mfma_f32_32x32x16_bf16 v[80:95], v[12:15], v[32:35], v[80:95]
    ds_read_b64_tr_b16 v[40:41], v52 offset:6144
    ds_read_b64_tr_b16 v[42:43], v52 offset:6656
    v_mfma_f32_32x32x16_bf16 v[96:111], v[12:15], v[36:39], v[96:111]
    ds_read_b64_tr_b16 v[44:45], v52 offset:14336
    ds_read_b64_tr_b16 v[46:47], v52 offset:14848
    v_mfma_f32_32x32x16_bf16 v[112:127], v[28:31], v[16:19], v[112:127]
    ds_read_b64_tr_b16 v[48:49], v52 offset:22528
    ds_read_b64_tr_b16 v[50:51], v52 offset:23040
    v_mfma_f32_32x32x16_bf16 v[128:143], v[16:19], v[32:35], v[128:143]
    v_mfma_f32_32x32x16_bf16 v[144:159], v[16:19], v[36:39], v[144:159]
    s_cmp_eq_u32 s61, 2
    s_cselect_b32 s67, 1, 0
    s_cmp_eq_u32 s61, 5
    s_cselect_b32 s67, 1, s67
    s_mov_b32 s64, 40960
    s_cmp_eq_u32 s67, 1
    s_cselect_b32 s64, 0xfffec000, s64
    v_add_u32 v5, s64, v5
    v_add_u32 v6, s64, v6
    v_add_u32 v7, s64, v7
    v_add_u32 v8, s64, v8
    v_add_u32 v52, s64, v52
    s_waitcnt lgkmcnt(0)
    s_barrier
    v_mfma_f32_32x32x16_bf16 v[64:79], v[40:43], v[20:23], v[64:79]
    ds_read_b128 v[12:15], v5 offset:0
    ds_read_b128 v[16:19], v5 offset:4096
    v_mfma_f32_32x32x16_bf16 v[80:95], v[20:23], v[44:47], v[80:95]
    ds_read_b64_tr_b16 v[28:29], v52 offset:0
    ds_read_b64_tr_b16 v[30:31], v52 offset:512
    v_mfma_f32_32x32x16_bf16 v[96:111], v[20:23], v[48:51], v[96:111]
    ds_read_b64_tr_b16 v[32:33], v52 offset:8192
    ds_read_b64_tr_b16 v[34:35], v52 offset:8704
    v_mfma_f32_32x32x16_bf16 v[112:127], v[40:43], v[24:27], v[112:127]
    ds_read_b64_tr_b16 v[36:37], v52 offset:16384
    ds_read_b64_tr_b16 v[38:39], v52 offset:16896
    v_mfma_f32_32x32x16_bf16 v[128:143], v[24:27], v[44:47], v[128:143]
    v_mfma_f32_32x32x16_bf16 v[144:159], v[24:27], v[48:51], v[144:159]
    s_add_u32 s61, s61, 1
    s_cmp_lt_u32 s61, 7
    s_cbranch_scc1 L1_loopA
    s_waitcnt lgkmcnt(0)
    v_lshlrev_b32 v10, 2, v0
    buffer_load_dword v9, v10, s[44:47], 0 offen sc1
    s_lshr_b32 s65, s54, 1
    s_lshl_b32 s65, s65, 1
    s_lshl_b32 s66, s56, 2
    s_add_u32 s68, s65, s66
    v_cmp_gt_u32 vcc, 32, v0
    v_and_b32 v11, 31, v0
    v_cmp_gt_u32 s[6:7], 28, v11
    v_mov_b32 v12, 0x3f803f80
    s_and_b32 s65, s54, 1
    s_lshl_b32 s66, s57, 1
    s_add_u32 s67, s65, s66
    s_mov_b32 s8, 0x3fb8aa3b
    s_mov_b32 s9, s8
    s_mov_b32 s10, 0x358637bd
    s_mov_b32 s11, s10
    s_mov_b32 s66, 0x358637bd
    v_pk_mul_f32 v[160:161], v[80:81], s[8:9]
    v_pk_mul_f32 v[162:163], v[82:83], s[8:9]
    v_exp_f32_e64 v160, v160 clamp
    v_exp_f32_e64 v161, v161 clamp
    v_exp_f32_e64 v162, v162 clamp
    v_exp_f32_e64 v163, v163 clamp
    v_max_f32 v80, 0, v80
    v_max_f32 v81, 0, v81
    v_max_f32 v82, 0, v82
    v_max_f32 v83, 0, v83
    v_pk_add_f32 v[160:161], v[160:161], s[10:11]
    v_pk_add_f32 v[162:163], v[162:163], s[10:11]
    v_pk_add_f32 v[80:81], v[160:161], v[80:81]
    v_pk_add_f32 v[82:83], v[162:163], v[82:83]
    v_pk_mul_f32 v[160:161], v[84:85], s[8:9]
    v_pk_mul_f32 v[162:163], v[86:87], s[8:9]
    v_exp_f32_e64 v160, v160 clamp
    v_exp_f32_e64 v161, v161 clamp
    v_exp_f32_e64 v162, v162 clamp
    v_exp_f32_e64 v163, v163 clamp
    v_max_f32 v84, 0, v84
    v_max_f32 v85, 0, v85
    v_max_f32 v86, 0, v86
    v_max_f32 v87, 0, v87
    v_pk_add_f32 v[160:161], v[160:161], s[10:11]
    v_pk_add_f32 v[162:163], v[162:163], s[10:11]
    v_pk_add_f32 v[84:85], v[160:161], v[84:85]
    v_pk_add_f32 v[86:87], v[162:163], v[86:87]
    v_pk_mul_f32 v[160:161], v[88:89], s[8:9]
    v_pk_mul_f32 v[162:163], v[90:91], s[8:9]
    v_exp_f32_e64 v160, v160 clamp
    v_exp_f32_e64 v161, v161 clamp
    v_exp_f32_e64 v162, v162 clamp
    v_exp_f32_e64 v163, v163 clamp
    v_max_f32 v88, 0, v88
    v_max_f32 v89, 0, v89
    v_max_f32 v90, 0, v90
    v_max_f32 v91, 0, v91
    v_pk_add_f32 v[160:161], v[160:161], s[10:11]
    v_pk_add_f32 v[162:163], v[162:163], s[10:11]
    v_pk_add_f32 v[88:89], v[160:161], v[88:89]
    v_pk_add_f32 v[90:91], v[162:163], v[90:91]
    v_pk_mul_f32 v[160:161], v[92:93], s[8:9]
    v_pk_mul_f32 v[162:163], v[94:95], s[8:9]
    v_exp_f32_e64 v160, v160 clamp
    v_exp_f32_e64 v161, v161 clamp
    v_exp_f32_e64 v162, v162 clamp
    v_exp_f32_e64 v163, v163 clamp
    v_max_f32 v92, 0, v92
    v_max_f32 v93, 0, v93
    v_max_f32 v94, 0, v94
    v_max_f32 v95, 0, v95
    v_pk_add_f32 v[160:161], v[160:161], s[10:11]
    v_pk_add_f32 v[162:163], v[162:163], s[10:11]
    v_pk_add_f32 v[92:93], v[160:161], v[92:93]
    v_pk_add_f32 v[94:95], v[162:163], v[94:95]
    v_cvt_pk_bf16_f32 v80, v80, v81
    v_cvt_pk_bf16_f32 v81, v82, v83
    v_cvt_pk_bf16_f32 v82, v84, v85
    v_cvt_pk_bf16_f32 v83, v86, v87
    v_cvt_pk_bf16_f32 v84, v88, v89
    v_cvt_pk_bf16_f32 v85, v90, v91
    v_cvt_pk_bf16_f32 v86, v92, v93
    v_cvt_pk_bf16_f32 v87, v94, v95
    v_cvt_pk_bf16_f32 v96, v96, v97
    v_cvt_pk_bf16_f32 v97, v98, v99
    v_cvt_pk_bf16_f32 v98, v100, v101
    v_cvt_pk_bf16_f32 v99, v102, v103
    v_cvt_pk_bf16_f32 v100, v104, v105
    v_cvt_pk_bf16_f32 v101, v106, v107
    v_cvt_pk_bf16_f32 v102, v108, v109
    v_cvt_pk_bf16_f32 v103, v110, v111
    v_cndmask_b32 v96, v12, v96, s[6:7]
    v_cndmask_b32 v97, v12, v97, s[6:7]
    v_cndmask_b32 v98, v12, v98, s[6:7]
    v_cndmask_b32 v99, v12, v99, s[6:7]
    v_cndmask_b32 v100, v12, v100, s[6:7]
    v_cndmask_b32 v101, v12, v101, s[6:7]
    v_cndmask_b32 v102, v12, v102, s[6:7]
    v_cndmask_b32 v103, v12, v103, s[6:7]
    s_nop 0
    v_mfma_f32_32x32x16_bf16 v[16:31], v[80:83], v[96:99], 0
    v_mfma_f32_32x32x16_bf16 v[16:31], v[84:87], v[100:103], v[16:31]
    v_pk_mul_f32 v[160:161], v[128:129], s[8:9]
    v_pk_mul_f32 v[162:163], v[130:131], s[8:9]
    v_exp_f32_e64 v160, v160 clamp
    v_exp_f32_e64 v161, v161 clamp
    v_exp_f32_e64 v162, v162 clamp
    v_exp_f32_e64 v163, v163 clamp
    v_max_f32 v128, 0, v128
    v_max_f32 v129, 0, v129
    v_max_f32 v130, 0, v130
    v_max_f32 v131, 0, v131
    v_pk_add_f32 v[160:161], v[160:161], s[10:11]
    v_pk_add_f32 v[162:163], v[162:163], s[10:11]
    v_pk_add_f32 v[128:129], v[160:161], v[128:129]
    v_pk_add_f32 v[130:131], v[162:163], v[130:131]
    v_pk_mul_f32 v[160:161], v[132:133], s[8:9]
    v_pk_mul_f32 v[162:163], v[134:135], s[8:9]
    v_exp_f32_e64 v160, v160 clamp
    v_exp_f32_e64 v161, v161 clamp
    v_exp_f32_e64 v162, v162 clamp
    v_exp_f32_e64 v163, v163 clamp
    v_max_f32 v132, 0, v132
    v_max_f32 v133, 0, v133
    v_max_f32 v134, 0, v134
    v_max_f32 v135, 0, v135
    v_pk_add_f32 v[160:161], v[160:161], s[10:11]
    v_pk_add_f32 v[162:163], v[162:163], s[10:11]
    v_pk_add_f32 v[132:133], v[160:161], v[132:133]
    v_pk_add_f32 v[134:135], v[162:163], v[134:135]
    v_pk_mul_f32 v[160:161], v[136:137], s[8:9]
    v_pk_mul_f32 v[162:163], v[138:139], s[8:9]
    v_exp_f32_e64 v160, v160 clamp
    v_exp_f32_e64 v161, v161 clamp
    v_exp_f32_e64 v162, v162 clamp
    v_exp_f32_e64 v163, v163 clamp
    v_max_f32 v136, 0, v136
    v_max_f32 v137, 0, v137
    v_max_f32 v138, 0, v138
    v_max_f32 v139, 0, v139
    v_pk_add_f32 v[160:161], v[160:161], s[10:11]
    v_pk_add_f32 v[162:163], v[162:163], s[10:11]
    v_pk_add_f32 v[136:137], v[160:161], v[136:137]
    v_pk_add_f32 v[138:139], v[162:163], v[138:139]
    v_pk_mul_f32 v[160:161], v[140:141], s[8:9]
    v_pk_mul_f32 v[162:163], v[142:143], s[8:9]
    v_exp_f32_e64 v160, v160 clamp
    v_exp_f32_e64 v161, v161 clamp
    v_exp_f32_e64 v162, v162 clamp
    v_exp_f32_e64 v163, v163 clamp
    v_max_f32 v140, 0, v140
    v_max_f32 v141, 0, v141
    v_max_f32 v142, 0, v142
    v_max_f32 v143, 0, v143
    v_pk_add_f32 v[160:161], v[160:161], s[10:11]
    v_pk_add_f32 v[162:163], v[162:163], s[10:11]
    v_pk_add_f32 v[140:141], v[160:161], v[140:141]
    v_pk_add_f32 v[142:143], v[162:163], v[142:143]
    v_cvt_pk_bf16_f32 v128, v128, v129
    v_cvt_pk_bf16_f32 v129, v130, v131
    v_cvt_pk_bf16_f32 v130, v132, v133
    v_cvt_pk_bf16_f32 v131, v134, v135
    v_cvt_pk_bf16_f32 v132, v136, v137
    v_cvt_pk_bf16_f32 v133, v138, v139
    v_cvt_pk_bf16_f32 v134, v140, v141
    v_cvt_pk_bf16_f32 v135, v142, v143
    v_cvt_pk_bf16_f32 v144, v144, v145
    v_cvt_pk_bf16_f32 v145, v146, v147
    v_cvt_pk_bf16_f32 v146, v148, v149
    v_cvt_pk_bf16_f32 v147, v150, v151
    v_cvt_pk_bf16_f32 v148, v152, v153
    v_cvt_pk_bf16_f32 v149, v154, v155
    v_cvt_pk_bf16_f32 v150, v156, v157
    v_cvt_pk_bf16_f32 v151, v158, v159
    v_cndmask_b32 v144, v12, v144, s[6:7]
    v_cndmask_b32 v145, v12, v145, s[6:7]
    v_cndmask_b32 v146, v12, v146, s[6:7]
    v_cndmask_b32 v147, v12, v147, s[6:7]
    v_cndmask_b32 v148, v12, v148, s[6:7]
    v_cndmask_b32 v149, v12, v149, s[6:7]
    v_cndmask_b32 v150, v12, v150, s[6:7]
    v_cndmask_b32 v151, v12, v151, s[6:7]
    s_nop 0
    v_mfma_f32_32x32x16_bf16 v[16:31], v[128:131], v[144:147], v[16:31]
    v_mfma_f32_32x32x16_bf16 v[16:31], v[132:135], v[148:151], v[16:31]
    s_and_b32 s69, s54, 1
    s_lshl_b32 s69, s69, 12
    s_add_u32 s69, s69, 123904
    v_add_u32 v11, s69, v1
    s_nop 11
    s_cmp_lt_u32 s54, 2
    s_cbranch_scc1 L1_lowwave
    ds_write_b128 v11, v[16:19] offset:0
    ds_write_b128 v11, v[20:23] offset:1024
    ds_write_b128 v11, v[24:27] offset:2048
    ds_write_b128 v11, v[28:31] offset:3072
    s_waitcnt vmcnt(0) lgkmcnt(0)
    s_barrier
    s_branch L1_kvdone
L1_lowwave:
    s_barrier
    ds_read_b128 v[160:163], v11 offset:0
    ds_read_b128 v[164:167], v11 offset:1024
    ds_read_b128 v[168:171], v11 offset:2048
    ds_read_b128 v[172:175], v11 offset:3072
    s_lshl_b32 s69, s67, 12
    s_add_u32 s69, s69, 0xc00000
    v_lshlrev_b32 v14, 2, v0
    s_waitcnt vmcnt(0) lgkmcnt(0)
    v_add_f32 v16, v160, v16
    v_add_f32 v17, v161, v17
    v_add_f32 v18, v162, v18
    v_add_f32 v19, v163, v19
    v_add_f32 v20, v164, v20
    v_add_f32 v21, v165, v21
    v_add_f32 v22, v166, v22
    v_add_f32 v23, v167, v23
    v_add_f32 v24, v168, v24
    v_add_f32 v25, v169, v25
    v_add_f32 v26, v170, v26
    v_add_f32 v27, v171, v27
    v_add_f32 v28, v172, v28
    v_add_f32 v29, v173, v29
    v_add_f32 v30, v174, v30
    v_add_f32 v31, v175, v31
    s_add_u32 s68, s57, 1
    s_mov_b32 s74, 0
L_zchk_1:
    v_readlane_b32 s70, v9, s68
    s_add_u32 s74, s74, 1
    s_cmp_gt_u32 s74, 400000
    s_cbranch_scc1 L1_zok
    s_cmp_lg_u32 s70, 0
    s_cbranch_scc1 L1_zok
    v_lshlrev_b32 v10, 2, v0
    buffer_load_dword v9, v10, s[44:47], 0 offen sc1
    s_waitcnt vmcnt(0)
    s_branch L_zchk_1
L1_zok:
    buffer_atomic_add_f32 v16, v14, s[32:35], s69 offen offset:0 sc1
    buffer_atomic_add_f32 v17, v14, s[32:35], s69 offen offset:256 sc1
    buffer_atomic_add_f32 v18, v14, s[32:35], s69 offen offset:512 sc1
    buffer_atomic_add_f32 v19, v14, s[32:35], s69 offen offset:768 sc1
    buffer_atomic_add_f32 v20, v14, s[32:35], s69 offen offset:1024 sc1
    buffer_atomic_add_f32 v21, v14, s[32:35], s69 offen offset:1280 sc1
    buffer_atomic_add_f32 v22, v14, s[32:35], s69 offen offset:1536 sc1
    buffer_atomic_add_f32 v23, v14, s[32:35], s69 offen offset:1792 sc1
    buffer_atomic_add_f32 v24, v14, s[32:35], s69 offen offset:2048 sc1
    buffer_atomic_add_f32 v25, v14, s[32:35], s69 offen offset:2304 sc1
    buffer_atomic_add_f32 v26, v14, s[32:35], s69 offen offset:2560 sc1
    buffer_atomic_add_f32 v27, v14, s[32:35], s69 offen offset:2816 sc1
    buffer_atomic_add_f32 v28, v14, s[32:35], s69 offen offset:3072 sc1
    buffer_atomic_add_f32 v29, v14, s[32:35], s69 offen offset:3328 sc1
    buffer_atomic_add_f32 v30, v14, s[32:35], s69 offen offset:3584 sc1
    buffer_atomic_add_f32 v31, v14, s[32:35], s69 offen offset:3840 sc1
L1_kvdone:
    v_readfirstlane_b32 s58, v9
    s_mov_b32 s74, 0
    s_nop 2
    s_cmp_lg_u32 s58, 0
    s_cbranch_scc1 L_nonce_2_x
L_nonce_2:
    v_lshlrev_b32 v10, 2, v0
    buffer_load_dword v9, v10, s[44:47], 0 offen sc1
    s_waitcnt vmcnt(0)
    v_readfirstlane_b32 s58, v9
    s_add_u32 s74, s74, 1
    s_cmp_gt_u32 s74, 400000
    s_cbranch_scc1 L_nonce_2_x
    s_cmp_eq_u32 s58, 0
    s_cbranch_scc1 L_nonce_2
L_nonce_2_x:
    s_mov_b32 s66, 0x358637bd
    v_cmp_gt_u32 vcc, 32, v0
    v_pk_mul_f32 v[160:161], v[64:65], s[8:9]
    v_pk_mul_f32 v[162:163], v[66:67], s[8:9]
    v_exp_f32_e64 v160, v160 clamp
    v_exp_f32_e64 v161, v161 clamp
    v_exp_f32_e64 v162, v162 clamp
    v_exp_f32_e64 v163, v163 clamp
    v_max_f32 v64, 0, v64
    v_max_f32 v65, 0, v65
    v_max_f32 v66, 0, v66
    v_max_f32 v67, 0, v67
    v_pk_add_f32 v[160:161], v[160:161], s[10:11]
    v_pk_add_f32 v[162:163], v[162:163], s[10:11]
    v_pk_add_f32 v[64:65], v[160:161], v[64:65]
    v_pk_add_f32 v[66:67], v[162:163], v[66:67]
    v_pk_mul_f32 v[160:161], v[68:69], s[8:9]
    v_pk_mul_f32 v[162:163], v[70:71], s[8:9]
    v_exp_f32_e64 v160, v160 clamp
    v_exp_f32_e64 v161, v161 clamp
    v_exp_f32_e64 v162, v162 clamp
    v_exp_f32_e64 v163, v163 clamp
    v_max_f32 v68, 0, v68
    v_max_f32 v69, 0, v69
    v_max_f32 v70, 0, v70
    v_max_f32 v71, 0, v71
    v_pk_add_f32 v[160:161], v[160:161], s[10:11]
    v_pk_add_f32 v[162:163], v[162:163], s[10:11]
    v_pk_add_f32 v[68:69], v[160:161], v[68:69]
    v_pk_add_f32 v[70:71], v[162:163], v[70:71]
    v_pk_mul_f32 v[160:161], v[72:73], s[8:9]
    v_pk_mul_f32 v[162:163], v[74:75], s[8:9]
    v_exp_f32_e64 v160, v160 clamp
    v_exp_f32_e64 v161, v161 clamp
    v_exp_f32_e64 v162, v162 clamp
    v_exp_f32_e64 v163, v163 clamp
    v_max_f32 v72, 0, v72
    v_max_f32 v73, 0, v73
    v_max_f32 v74, 0, v74
    v_max_f32 v75, 0, v75
    v_pk_add_f32 v[160:161], v[160:161], s[10:11]
    v_pk_add_f32 v[162:163], v[162:163], s[10:11]
    v_pk_add_f32 v[72:73], v[160:161], v[72:73]
    v_pk_add_f32 v[74:75], v[162:163], v[74:75]
    v_pk_mul_f32 v[160:161], v[76:77], s[8:9]
    v_pk_mul_f32 v[162:163], v[78:79], s[8:9]
    v_exp_f32_e64 v160, v160 clamp
    v_exp_f32_e64 v161, v161 clamp
    v_exp_f32_e64 v162, v162 clamp
    v_exp_f32_e64 v163, v163 clamp
    v_max_f32 v76, 0, v76
    v_max_f32 v77, 0, v77
    v_max_f32 v78, 0, v78
    v_max_f32 v79, 0, v79
    v_pk_add_f32 v[160:161], v[160:161], s[10:11]
    v_pk_add_f32 v[162:163], v[162:163], s[10:11]
    v_pk_add_f32 v[76:77], v[160:161], v[76:77]
    v_pk_add_f32 v[78:79], v[162:163], v[78:79]
    v_cvt_pk_bf16_f32 v64, v64, v65
    v_cvt_pk_bf16_f32 v65, v66, v67
    v_cvt_pk_bf16_f32 v66, v68, v69
    v_cvt_pk_bf16_f32 v67, v70, v71
    v_cvt_pk_bf16_f32 v68, v72, v73
    v_cvt_pk_bf16_f32 v69, v74, v75
    v_cvt_pk_bf16_f32 v70, v76, v77
    v_cvt_pk_bf16_f32 v71, v78, v79
    v_cndmask_b32 v70, 0, v70, vcc
    v_cndmask_b32 v71, 0, v71, vcc
    s_lshl_b32 s68, s54, 12
    v_add_u32 v11, s68, v1
    ds_write_b128 v11, v[64:67] offset:0
    ds_write_b128 v11, v[68:71] offset:1024
    v_pk_mul_f32 v[160:161], v[112:113], s[8:9]
    v_pk_mul_f32 v[162:163], v[114:115], s[8:9]
    v_exp_f32_e64 v160, v160 clamp
    v_exp_f32_e64 v161, v161 clamp
    v_exp_f32_e64 v162, v162 clamp
    v_exp_f32_e64 v163, v163 clamp
    v_max_f32 v112, 0, v112
    v_max_f32 v113, 0, v113
    v_max_f32 v114, 0, v114
    v_max_f32 v115, 0, v115
    v_pk_add_f32 v[160:161], v[160:161], s[10:11]
    v_pk_add_f32 v[162:163], v[162:163], s[10:11]
    v_pk_add_f32 v[112:113], v[160:161], v[112:113]
    v_pk_add_f32 v[114:115], v[162:163], v[114:115]
    v_pk_mul_f32 v[160:161], v[116:117], s[8:9]
    v_pk_mul_f32 v[162:163], v[118:119], s[8:9]
    v_exp_f32_e64 v160, v160 clamp
    v_exp_f32_e64 v161, v161 clamp
    v_exp_f32_e64 v162, v162 clamp
    v_exp_f32_e64 v163, v163 clamp
    v_max_f32 v116, 0, v116
    v_max_f32 v117, 0, v117
    v_max_f32 v118, 0, v118
    v_max_f32 v119, 0, v119
    v_pk_add_f32 v[160:161], v[160:161], s[10:11]
    v_pk_add_f32 v[162:163], v[162:163], s[10:11]
    v_pk_add_f32 v[116:117], v[160:161], v[116:117]
    v_pk_add_f32 v[118:119], v[162:163], v[118:119]
    v_pk_mul_f32 v[160:161], v[120:121], s[8:9]
    v_pk_mul_f32 v[162:163], v[122:123], s[8:9]
    v_exp_f32_e64 v160, v160 clamp
    v_exp_f32_e64 v161, v161 clamp
    v_exp_f32_e64 v162, v162 clamp
    v_exp_f32_e64 v163, v163 clamp
    v_max_f32 v120, 0, v120
    v_max_f32 v121, 0, v121
    v_max_f32 v122, 0, v122
    v_max_f32 v123, 0, v123
    v_pk_add_f32 v[160:161], v[160:161], s[10:11]
    v_pk_add_f32 v[162:163], v[162:163], s[10:11]
    v_pk_add_f32 v[120:121], v[160:161], v[120:121]
    v_pk_add_f32 v[122:123], v[162:163], v[122:123]
    v_pk_mul_f32 v[160:161], v[124:125], s[8:9]
    v_pk_mul_f32 v[162:163], v[126:127], s[8:9]
    v_exp_f32_e64 v160, v160 clamp
    v_exp_f32_e64 v161, v161 clamp
    v_exp_f32_e64 v162, v162 clamp
    v_exp_f32_e64 v163, v163 clamp
    v_max_f32 v124, 0, v124
    v_max_f32 v125, 0, v125
    v_max_f32 v126, 0, v126
    v_max_f32 v127, 0, v127
    v_pk_add_f32 v[160:161], v[160:161], s[10:11]
    v_pk_add_f32 v[162:163], v[162:163], s[10:11]
    v_pk_add_f32 v[124:125], v[160:161], v[124:125]
    v_pk_add_f32 v[126:127], v[162:163], v[126:127]
    v_cvt_pk_bf16_f32 v112, v112, v113
    v_cvt_pk_bf16_f32 v113, v114, v115
    v_cvt_pk_bf16_f32 v114, v116, v117
    v_cvt_pk_bf16_f32 v115, v118, v119
    v_cvt_pk_bf16_f32 v116, v120, v121
    v_cvt_pk_bf16_f32 v117, v122, v123
    v_cvt_pk_bf16_f32 v118, v124, v125
    v_cvt_pk_bf16_f32 v119, v126, v127
    v_cndmask_b32 v118, 0, v118, vcc
    v_cndmask_b32 v119, 0, v119, vcc
    ds_write_b128 v11, v[112:115] offset:2048
    ds_write_b128 v11, v[116:119] offset:3072
    s_waitcnt lgkmcnt(0)
    s_cmp_lt_u32 s54, 2
    s_cbranch_scc0 L2_start
    s_lshl_b32 s65, s67, 4
    s_add_u32 s65, s65, s56
    s_lshl_b32 s65, s65, 7
    s_add_u32 s65, s65, 0xd40000
    s_waitcnt vmcnt(0)
    v_mov_b32 v10, 0
    v_mov_b32 v11, s58
    s_mov_b64 exec, 1
    buffer_store_dword v11, v10, s[32:35], s65 offen sc1
    s_mov_b64 exec, -1
    s_branch L2_start
L1_B:
    s_mul_i32 s66, s57, 336
    s_and_b32 s66, s66, 127
    v_lshrrev_b32 v12, 5, v0
    v_bfe_u32 v13, v0, 2, 2
    v_lshl_add_u32 v14, v12, 3, v13
    v_lshlrev_b32 v14, 9, v14
    v_add_u32 v14, 16384, v14
    v_bfe_u32 v15, v0, 4, 1
    v_lshlrev_b32 v15, 5, v15
    v_and_b32 v16, 3, v0
    v_lshl_add_u32 v15, v16, 3, v15
    s_and_b32 s65, s54, 1
    s_mul_i32 s65, s65, 168
    s_add_u32 s65, s65, s66
    v_add_u32 v15, s65, v15
    v_lshlrev_b32 v13, 6, v13
    v_add_u32 v16, 0, v15
    v_xor_b32 v16, v16, v13
    v_add_u32 v52, v14, v16
    v_add_u32 v16, 56, v15
    v_xor_b32 v16, v16, v13
    v_add_u32 v53, v14, v16
    v_add_u32 v16, 112, v15
    v_xor_b32 v16, v16, v13
    v_add_u32 v54, v14, v16
    s_and_b32 s65, s54, 1
    s_mul_i32 s65, s65, 3
    s_mul_i32 s66, s57, 6
    s_add_u32 s71, s65, s66
    s_barrier
    ds_read_b128 v[12:15], v5 offset:0
    ds_read_b128 v[16:19], v5 offset:4096
    ds_read_b64_tr_b16 v[28:29], v52 offset:0
    ds_read_b64_tr_b16 v[30:31], v52 offset:2048
    ds_read_b64_tr_b16 v[32:33], v53 offset:0
    ds_read_b64_tr_b16 v[34:35], v53 offset:2048
    ds_read_b64_tr_b16 v[36:37], v54 offset:0
    ds_read_b64_tr_b16 v[38:39], v54 offset:2048
    s_cmp_eq_u32 s71, 30
    s_cbranch_scc1 L1_loopTTN
    s_cmp_gt_u32 s71, 30
    s_cbranch_scc1 L1_loopNNN
L1_loopTTT:
    s_waitcnt lgkmcnt(0)
    v_mfma_f32_32x32x16_bf16 v[64:79], v[28:31], v[12:15], v[64:79]
    ds_read_b128 v[20:23], v6 offset:0
    ds_read_b128 v[24:27], v6 offset:4096
    v_mfma_f32_32x32x16_bf16 v[80:95], v[32:35], v[12:15], v[80:95]
    ds_read_b64_tr_b16 v[40:41], v52 offset:8192
    ds_read_b64_tr_b16 v[42:43], v52 offset:10240
    v_mfma_f32_32x32x16_bf16 v[96:111], v[36:39], v[12:15], v[96:111]
    ds_read_b64_tr_b16 v[44:45], v53 offset:8192
    ds_read_b64_tr_b16 v[46:47], v53 offset:10240
    v_mfma_f32_32x32x16_bf16 v[112:127], v[28:31], v[16:19], v[112:127]
    ds_read_b64_tr_b16 v[48:49], v54 offset:8192
    ds_read_b64_tr_b16 v[50:51], v54 offset:10240
    v_mfma_f32_32x32x16_bf16 v[128:143], v[32:35], v[16:19], v[128:143]
    v_mfma_f32_32x32x16_bf16 v[144:159], v[36:39], v[16:19], v[144:159]
    s_waitcnt lgkmcnt(0)
    v_mfma_f32_32x32x16_bf16 v[64:79], v[40:43], v[20:23], v[64:79]
    ds_read_b128 v[12:15], v7 offset:0
    ds_read_b128 v[16:19], v7 offset:4096
    v_mfma_f32_32x32x16_bf16 v[80:95], v[44:47], v[20:23], v[80:95]
    ds_read_b64_tr_b16 v[28:29], v52 offset:16384
    ds_read_b64_tr_b16 v[30:31], v52 offset:18432
    v_mfma_f32_32x32x16_bf16 v[96:111], v[48:51], v[20:23], v[96:111]
    ds_read_b64_tr_b16 v[32:33], v53 offset:16384
    ds_read_b64_tr_b16 v[34:35], v53 offset:18432
    v_mfma_f32_32x32x16_bf16 v[112:127], v[40:43], v[24:27], v[112:127]
    ds_read_b64_tr_b16 v[36:37], v54 offset:16384
    ds_read_b64_tr_b16 v[38:39], v54 offset:18432
    v_mfma_f32_32x32x16_bf16 v[128:143], v[44:47], v[24:27], v[128:143]
    v_mfma_f32_32x32x16_bf16 v[144:159], v[48:51], v[24:27], v[144:159]
    s_waitcnt lgkmcnt(0)
    v_mfma_f32_32x32x16_bf16 v[64:79], v[28:31], v[12:15], v[64:79]
    ds_read_b128 v[20:23], v8 offset:0
    ds_read_b128 v[24:27], v8 offset:4096
    v_mfma_f32_32x32x16_bf16 v[80:95], v[32:35], v[12:15], v[80:95]
    ds_read_b64_tr_b16 v[40:41], v52 offset:24576
    ds_read_b64_tr_b16 v[42:43], v52 offset:26624
    v_mfma_f32_32x32x16_bf16 v[96:111], v[36:39], v[12:15], v[96:111]
    ds_read_b64_tr_b16 v[44:45], v53 offset:24576
    ds_read_b64_tr_b16 v[46:47], v53 offset:26624
    v_mfma_f32_32x32x16_bf16 v[112:127], v[28:31], v[16:19], v[112:127]
    ds_read_b64_tr_b16 v[48:49], v54 offset:24576
    ds_read_b64_tr_b16 v[50:51], v54 offset:26624
    v_mfma_f32_32x32x16_bf16 v[128:143], v[32:35], v[16:19], v[128:143]
    v_mfma_f32_32x32x16_bf16 v[144:159], v[36:39], v[16:19], v[144:159]
    s_cmp_eq_u32 s61, 2
    s_cselect_b32 s67, 1, 0
    s_cmp_eq_u32 s61, 5
    s_cselect_b32 s67, 1, s67
    s_mov_b32 s64, 49152
    s_cmp_eq_u32 s67, 1
    s_cselect_b32 s64, 0xfffe8000, s64
    v_add_u32 v5, s64, v5
    v_add_u32 v6, s64, v6
    v_add_u32 v7, s64, v7
    v_add_u32 v8, s64, v8
    v_add_u32 v52, s64, v52
    v_add_u32 v53, s64, v53
    v_add_u32 v54, s64, v54
    s_waitcnt lgkmcnt(0)
    s_barrier
    v_mfma_f32_32x32x16_bf16 v[64:79], v[40:43], v[20:23], v[64:79]
    ds_read_b128 v[12:15], v5 offset:0
    ds_read_b128 v[16:19], v5 offset:4096
    v_mfma_f32_32x32x16_bf16 v[80:95], v[44:47], v[20:23], v[80:95]
    ds_read_b64_tr_b16 v[28:29], v52 offset:0
    ds_read_b64_tr_b16 v[30:31], v52 offset:2048
    v_mfma_f32_32x32x16_bf16 v[96:111], v[48:51], v[20:23], v[96:111]
    ds_read_b64_tr_b16 v[32:33], v53 offset:0
    ds_read_b64_tr_b16 v[34:35], v53 offset:2048
    v_mfma_f32_32x32x16_bf16 v[112:127], v[40:43], v[24:27], v[112:127]
    ds_read_b64_tr_b16 v[36:37], v54 offset:0
    ds_read_b64_tr_b16 v[38:39], v54 offset:2048
    v_mfma_f32_32x32x16_bf16 v[128:143], v[44:47], v[24:27], v[128:143]
    v_mfma_f32_32x32x16_bf16 v[144:159], v[48:51], v[24:27], v[144:159]
    s_add_u32 s61, s61, 1
    s_cmp_lt_u32 s61, 7
    s_cbranch_scc1 L1_loopTTT
    s_branch L1_Bepi
L1_loopTTN:
    s_waitcnt lgkmcnt(0)
    v_mfma_f32_32x32x16_bf16 v[64:79], v[28:31], v[12:15], v[64:79]
    ds_read_b128 v[20:23], v6 offset:0
    ds_read_b128 v[24:27], v6 offset:4096
    v_mfma_f32_32x32x16_bf16 v[80:95], v[32:35], v[12:15], v[80:95]
    ds_read_b64_tr_b16 v[40:41], v52 offset:8192
    ds_read_b64_tr_b16 v[42:43], v52 offset:10240
    v_mfma_f32_32x32x16_bf16 v[96:111], v[12:15], v[36:39], v[96:111]
    ds_read_b64_tr_b16 v[44:45], v53 offset:8192
    ds_read_b64_tr_b16 v[46:47], v53 offset:10240
    v_mfma_f32_32x32x16_bf16 v[112:127], v[28:31], v[16:19], v[112:127]
    ds_read_b64_tr_b16 v[48:49], v54 offset:8192
    ds_read_b64_tr_b16 v[50:51], v54 offset:10240
    v_mfma_f32_32x32x16_bf16 v[128:143], v[32:35], v[16:19], v[128:143]
    v_mfma_f32_32x32x16_bf16 v[144:159], v[16:19], v[36:39], v[144:159]
    s_waitcnt lgkmcnt(0)
    v_mfma_f32_32x32x16_bf16 v[64:79], v[40:43], v[20:23], v[64:79]
    ds_read_b128 v[12:15], v7 offset:0
    ds_read_b128 v[16:19], v7 offset:4096
    v_mfma_f32_32x32x16_bf16 v[80:95], v[44:47], v[20:23], v[80:95]
    ds_read_b64_tr_b16 v[28:29], v52 offset:16384
    ds_read_b64_tr_b16 v[30:31], v52 offset:18432
    v_mfma_f32_32x32x16_bf16 v[96:111], v[20:23], v[48:51], v[96:111]
    ds_read_b64_tr_b16 v[32:33], v53 offset:16384
    ds_read_b64_tr_b16 v[34:35], v53 offset:18432
    v_mfma_f32_32x32x16_bf16 v[112:127], v[40:43], v[24:27], v[112:127]
    ds_read_b64_tr_b16 v[36:37], v54 offset:16384
    ds_read_b64_tr_b16 v[38:39], v54 offset:18432
    v_mfma_f32_32x32x16_bf16 v[128:143], v[44:47], v[24:27], v[128:143]
    v_mfma_f32_32x32x16_bf16 v[144:159], v[24:27], v[48:51], v[144:159]
    s_waitcnt lgkmcnt(0)
    v_mfma_f32_32x32x16_bf16 v[64:79], v[28:31], v[12:15], v[64:79]
    ds_read_b128 v[20:23], v8 offset:0
    ds_read_b128 v[24:27], v8 offset:4096
    v_mfma_f32_32x32x16_bf16 v[80:95], v[32:35], v[12:15], v[80:95]
    ds_read_b64_tr_b16 v[40:41], v52 offset:24576
    ds_read_b64_tr_b16 v[42:43], v52 offset:26624
    v_mfma_f32_32x32x16_bf16 v[96:111], v[12:15], v[36:39], v[96:111]
    ds_read_b64_tr_b16 v[44:45], v53 offset:24576
    ds_read_b64_tr_b16 v[46:47], v53 offset:26624
    v_mfma_f32_32x32x16_bf16 v[112:127], v[28:31], v[16:19], v[112:127]
    ds_read_b64_tr_b16 v[48:49], v54 offset:24576
    ds_read_b64_tr_b16 v[50:51], v54 offset:26624
    v_mfma_f32_32x32x16_bf16 v[128:143], v[32:35], v[16:19], v[128:143]
    v_mfma_f32_32x32x16_bf16 v[144:159], v[16:19], v[36:39], v[144:159]
    s_cmp_eq_u32 s61, 2
    s_cselect_b32 s67, 1, 0
    s_cmp_eq_u32 s61, 5
    s_cselect_b32 s67, 1, s67
    s_mov_b32 s64, 49152
    s_cmp_eq_u32 s67, 1
    s_cselect_b32 s64, 0xfffe8000, s64
    v_add_u32 v5, s64, v5
    v_add_u32 v6, s64, v6
    v_add_u32 v7, s64, v7
    v_add_u32 v8, s64, v8
    v_add_u32 v52, s64, v52
    v_add_u32 v53, s64, v53
    v_add_u32 v54, s64, v54
    s_waitcnt lgkmcnt(0)
    s_barrier
    v_mfma_f32_32x32x16_bf16 v[64:79], v[40:43], v[20:23], v[64:79]
    ds_read_b128 v[12:15], v5 offset:0
    ds_read_b128 v[16:19], v5 offset:4096
    v_mfma_f32_32x32x16_bf16 v[80:95], v[44:47], v[20:23], v[80:95]
    ds_read_b64_tr_b16 v[28:29], v52 offset:0
    ds_read_b64_tr_b16 v[30:31], v52 offset:2048
    v_mfma_f32_32x32x16_bf16 v[96:111], v[20:23], v[48:51], v[96:111]
    ds_read_b64_tr_b16 v[32:33], v53 offset:0
    ds_read_b64_tr_b16 v[34:35], v53 offset:2048
    v_mfma_f32_32x32x16_bf16 v[112:127], v[40:43], v[24:27], v[112:127]
    ds_read_b64_tr_b16 v[36:37], v54 offset:0
    ds_read_b64_tr_b16 v[38:39], v54 offset:2048
    v_mfma_f32_32x32x16_bf16 v[128:143], v[44:47], v[24:27], v[128:143]
    v_mfma_f32_32x32x16_bf16 v[144:159], v[24:27], v[48:51], v[144:159]
    s_add_u32 s61, s61, 1
    s_cmp_lt_u32 s61, 7
    s_cbranch_scc1 L1_loopTTN
    s_branch L1_Bepi
L1_loopNNN:
    s_waitcnt lgkmcnt(0)
    v_mfma_f32_32x32x16_bf16 v[64:79], v[12:15], v[28:31], v[64:79]
    ds_read_b128 v[20:23], v6 offset:0
    ds_read_b128 v[24:27], v6 offset:4096
    v_mfma_f32_32x32x16_bf16 v[80:95], v[12:15], v[32:35], v[80:95]
    ds_read_b64_tr_b16 v[40:41], v52 offset:8192
    ds_read_b64_tr_b16 v[42:43], v52 offset:10240
    v_mfma_f32_32x32x16_bf16 v[96:111], v[12:15], v[36:39], v[96:111]
    ds_read_b64_tr_b16 v[44:45], v53 offset:8192
    ds_read_b64_tr_b16 v[46:47], v53 offset:10240
    v_mfma_f32_32x32x16_bf16 v[112:127], v[16:19], v[28:31], v[112:127]
    ds_read_b64_tr_b16 v[48:49], v54 offset:8192
    ds_read_b64_tr_b16 v[50:51], v54 offset:10240
    v_mfma_f32_32x32x16_bf16 v[128:143], v[16:19], v[32:35], v[128:143]
    v_mfma_f32_32x32x16_bf16 v[144:159], v[16:19], v[36:39], v[144:159]
    s_waitcnt lgkmcnt(0)
    v_mfma_f32_32x32x16_bf16 v[64:79], v[20:23], v[40:43], v[64:79]
    ds_read_b128 v[12:15], v7 offset:0
    ds_read_b128 v[16:19], v7 offset:4096
    v_mfma_f32_32x32x16_bf16 v[80:95], v[20:23], v[44:47], v[80:95]
    ds_read_b64_tr_b16 v[28:29], v52 offset:16384
    ds_read_b64_tr_b16 v[30:31], v52 offset:18432
    v_mfma_f32_32x32x16_bf16 v[96:111], v[20:23], v[48:51], v[96:111]
    ds_read_b64_tr_b16 v[32:33], v53 offset:16384
    ds_read_b64_tr_b16 v[34:35], v53 offset:18432
    v_mfma_f32_32x32x16_bf16 v[112:127], v[24:27], v[40:43], v[112:127]
    ds_read_b64_tr_b16 v[36:37], v54 offset:16384
    ds_read_b64_tr_b16 v[38:39], v54 offset:18432
    v_mfma_f32_32x32x16_bf16 v[128:143], v[24:27], v[44:47], v[128:143]
    v_mfma_f32_32x32x16_bf16 v[144:159], v[24:27], v[48:51], v[144:159]
    s_waitcnt lgkmcnt(0)
    v_mfma_f32_32x32x16_bf16 v[64:79], v[12:15], v[28:31], v[64:79]
    ds_read_b128 v[20:23], v8 offset:0
    ds_read_b128 v[24:27], v8 offset:4096
    v_mfma_f32_32x32x16_bf16 v[80:95], v[12:15], v[32:35], v[80:95]
    ds_read_b64_tr_b16 v[40:41], v52 offset:24576
    ds_read_b64_tr_b16 v[42:43], v52 offset:26624
    v_mfma_f32_32x32x16_bf16 v[96:111], v[12:15], v[36:39], v[96:111]
    ds_read_b64_tr_b16 v[44:45], v53 offset:24576
    ds_read_b64_tr_b16 v[46:47], v53 offset:26624
    v_mfma_f32_32x32x16_bf16 v[112:127], v[16:19], v[28:31], v[112:127]
    ds_read_b64_tr_b16 v[48:49], v54 offset:24576
    ds_read_b64_tr_b16 v[50:51], v54 offset:26624
    v_mfma_f32_32x32x16_bf16 v[128:143], v[16:19], v[32:35], v[128:143]
    v_mfma_f32_32x32x16_bf16 v[144:159], v[16:19], v[36:39], v[144:159]
    s_cmp_eq_u32 s61, 2
    s_cselect_b32 s67, 1, 0
    s_cmp_eq_u32 s61, 5
    s_cselect_b32 s67, 1, s67
    s_mov_b32 s64, 49152
    s_cmp_eq_u32 s67, 1
    s_cselect_b32 s64, 0xfffe8000, s64
    v_add_u32 v5, s64, v5
    v_add_u32 v6, s64, v6
    v_add_u32 v7, s64, v7
    v_add_u32 v8, s64, v8
    v_add_u32 v52, s64, v52
    v_add_u32 v53, s64, v53
    v_add_u32 v54, s64, v54
    s_waitcnt lgkmcnt(0)
    s_barrier
    v_mfma_f32_32x32x16_bf16 v[64:79], v[20:23], v[40:43], v[64:79]
    ds_read_b128 v[12:15], v5 offset:0
    ds_read_b128 v[16:19], v5 offset:4096
    v_mfma_f32_32x32x16_bf16 v[80:95], v[20:23], v[44:47], v[80:95]
    ds_read_b64_tr_b16 v[28:29], v52 offset:0
    ds_read_b64_tr_b16 v[30:31], v52 offset:2048
    v_mfma_f32_32x32x16_bf16 v[96:111], v[20:23], v[48:51], v[96:111]
    ds_read_b64_tr_b16 v[32:33], v53 offset:0
    ds_read_b64_tr_b16 v[34:35], v53 offset:2048
    v_mfma_f32_32x32x16_bf16 v[112:127], v[24:27], v[40:43], v[112:127]
    ds_read_b64_tr_b16 v[36:37], v54 offset:0
    ds_read_b64_tr_b16 v[38:39], v54 offset:2048
    v_mfma_f32_32x32x16_bf16 v[128:143], v[24:27], v[44:47], v[128:143]
    v_mfma_f32_32x32x16_bf16 v[144:159], v[24:27], v[48:51], v[144:159]
    s_add_u32 s61, s61, 1
    s_cmp_lt_u32 s61, 7
    s_cbranch_scc1 L1_loopNNN
L1_Bepi:
    s_waitcnt lgkmcnt(0)
    v_lshlrev_b32 v10, 2, v0
    buffer_load_dword v9, v10, s[44:47], 0 offen sc1
    s_lshr_b32 s65, s54, 1
    s_lshl_b32 s65, s65, 1
    s_lshl_b32 s66, s56, 2
    s_add_u32 s68, s65, s66
    v_cmp_gt_u32 vcc, 32, v0
    v_and_b32 v11, 31, v0
    v_cmp_gt_u32 s[6:7], 28, v11
    v_mov_b32 v12, 0x3f803f80
    s_nop 4
    s_add_u32 s65, s71, 0
    s_lshr_b32 s66, s65, 4
    s_and_b32 s65, s65, 15
    s_lshl_b32 s65, s65, 17
    s_lshl_b32 s67, s66, 21
    s_add_u32 s65, s65, s67
    s_lshl_b32 s67, s68, 11
    s_add_u32 s69, s65, s67
    s_cmp_eq_u32 s66, 2
    s_cbranch_scc1 L1_N_3
    s_cmp_eq_u32 s66, 0
    s_cselect_b32 s4, 0x3e8b97f6, 1.0
    s_cselect_b32 s67, 0x3f80, 0
    s_mov_b32 s5, s4
    v_mov_b32 v13, s67
    v_pk_mul_f32 v[64:65], v[64:65], s[4:5]
    v_pk_mul_f32 v[66:67], v[66:67], s[4:5]
    v_pk_mul_f32 v[68:69], v[68:69], s[4:5]
    v_pk_mul_f32 v[70:71], v[70:71], s[4:5]
    v_pk_mul_f32 v[72:73], v[72:73], s[4:5]
    v_pk_mul_f32 v[74:75], v[74:75], s[4:5]
    v_pk_mul_f32 v[76:77], v[76:77], s[4:5]
    v_pk_mul_f32 v[78:79], v[78:79], s[4:5]
    v_cvt_pk_bf16_f32 v64, v64, v65
    v_cvt_pk_bf16_f32 v65, v66, v67
    v_cvt_pk_bf16_f32 v66, v68, v69
    v_cvt_pk_bf16_f32 v67, v70, v71
    v_cvt_pk_bf16_f32 v68, v72, v73
    v_cvt_pk_bf16_f32 v69, v74, v75
    v_cvt_pk_bf16_f32 v70, v76, v77
    v_cvt_pk_bf16_f32 v71, v78, v79
    v_cndmask_b32 v70, v13, v70, vcc
    v_cndmask_b32 v71, 0, v71, vcc
    buffer_store_dwordx4 v[64:67], v1, s[32:35], s69 offen offset:0 sc1
    buffer_store_dwordx4 v[68:71], v1, s[32:35], s69 offen offset:1024 sc1
    v_pk_mul_f32 v[112:113], v[112:113], s[4:5]
    v_pk_mul_f32 v[114:115], v[114:115], s[4:5]
    v_pk_mul_f32 v[116:117], v[116:117], s[4:5]
    v_pk_mul_f32 v[118:119], v[118:119], s[4:5]
    v_pk_mul_f32 v[120:121], v[120:121], s[4:5]
    v_pk_mul_f32 v[122:123], v[122:123], s[4:5]
    v_pk_mul_f32 v[124:125], v[124:125], s[4:5]
    v_pk_mul_f32 v[126:127], v[126:127], s[4:5]
    v_cvt_pk_bf16_f32 v112, v112, v113
    v_cvt_pk_bf16_f32 v113, v114, v115
    v_cvt_pk_bf16_f32 v114, v116, v117
    v_cvt_pk_bf16_f32 v115, v118, v119
    v_cvt_pk_bf16_f32 v116, v120, v121
    v_cvt_pk_bf16_f32 v117, v122, v123
    v_cvt_pk_bf16_f32 v118, v124, v125
    v_cvt_pk_bf16_f32 v119, v126, v127
    v_cndmask_b32 v118, v13, v118, vcc
    v_cndmask_b32 v119, 0, v119, vcc
    buffer_store_dwordx4 v[112:115], v1, s[32:35], s69 offen offset:2048 sc1
    buffer_store_dwordx4 v[116:119], v1, s[32:35], s69 offen offset:3072 sc1
    s_branch L1_D_4
L1_N_3:
    v_cvt_pk_bf16_f32 v64, v64, v65
    v_cvt_pk_bf16_f32 v65, v66, v67
    v_cvt_pk_bf16_f32 v66, v68, v69
    v_cvt_pk_bf16_f32 v67, v70, v71
    v_cvt_pk_bf16_f32 v68, v72, v73
    v_cvt_pk_bf16_f32 v69, v74, v75
    v_cvt_pk_bf16_f32 v70, v76, v77
    v_cvt_pk_bf16_f32 v71, v78, v79
    v_cndmask_b32 v64, v12, v64, s[6:7]
    v_cndmask_b32 v65, v12, v65, s[6:7]
    v_cndmask_b32 v66, v12, v66, s[6:7]
    v_cndmask_b32 v67, v12, v67, s[6:7]
    v_cndmask_b32 v68, v12, v68, s[6:7]
    v_cndmask_b32 v69, v12, v69, s[6:7]
    v_cndmask_b32 v70, v12, v70, s[6:7]
    v_cndmask_b32 v71, v12, v71, s[6:7]
    buffer_store_dwordx4 v[64:67], v1, s[32:35], s69 offen offset:0 sc1
    buffer_store_dwordx4 v[68:71], v1, s[32:35], s69 offen offset:1024 sc1
    v_cvt_pk_bf16_f32 v112, v112, v113
    v_cvt_pk_bf16_f32 v113, v114, v115
    v_cvt_pk_bf16_f32 v114, v116, v117
    v_cvt_pk_bf16_f32 v115, v118, v119
    v_cvt_pk_bf16_f32 v116, v120, v121
    v_cvt_pk_bf16_f32 v117, v122, v123
    v_cvt_pk_bf16_f32 v118, v124, v125
    v_cvt_pk_bf16_f32 v119, v126, v127
    v_cndmask_b32 v112, v12, v112, s[6:7]
    v_cndmask_b32 v113, v12, v113, s[6:7]
    v_cndmask_b32 v114, v12, v114, s[6:7]
    v_cndmask_b32 v115, v12, v115, s[6:7]
    v_cndmask_b32 v116, v12, v116, s[6:7]
    v_cndmask_b32 v117, v12, v117, s[6:7]
    v_cndmask_b32 v118, v12, v118, s[6:7]
    v_cndmask_b32 v119, v12, v119, s[6:7]
    buffer_store_dwordx4 v[112:115], v1, s[32:35], s69 offen offset:2048 sc1
    buffer_store_dwordx4 v[116:119], v1, s[32:35], s69 offen offset:3072 sc1
L1_D_4:
    s_add_u32 s65, s71, 1
    s_lshr_b32 s66, s65, 4
    s_and_b32 s65, s65, 15
    s_lshl_b32 s65, s65, 17
    s_lshl_b32 s67, s66, 21
    s_add_u32 s65, s65, s67
    s_lshl_b32 s67, s68, 11
    s_add_u32 s69, s65, s67
    s_cmp_eq_u32 s66, 2
    s_cbranch_scc1 L1_N_5
    s_cmp_eq_u32 s66, 0
    s_cselect_b32 s4, 0x3e8b97f6, 1.0
    s_cselect_b32 s67, 0x3f80, 0
    s_mov_b32 s5, s4
    v_mov_b32 v13, s67
    v_pk_mul_f32 v[80:81], v[80:81], s[4:5]
    v_pk_mul_f32 v[82:83], v[82:83], s[4:5]
    v_pk_mul_f32 v[84:85], v[84:85], s[4:5]
    v_pk_mul_f32 v[86:87], v[86:87], s[4:5]
    v_pk_mul_f32 v[88:89], v[88:89], s[4:5]
    v_pk_mul_f32 v[90:91], v[90:91], s[4:5]
    v_pk_mul_f32 v[92:93], v[92:93], s[4:5]
    v_pk_mul_f32 v[94:95], v[94:95], s[4:5]
    v_cvt_pk_bf16_f32 v80, v80, v81
    v_cvt_pk_bf16_f32 v81, v82, v83
    v_cvt_pk_bf16_f32 v82, v84, v85
    v_cvt_pk_bf16_f32 v83, v86, v87
    v_cvt_pk_bf16_f32 v84, v88, v89
    v_cvt_pk_bf16_f32 v85, v90, v91
    v_cvt_pk_bf16_f32 v86, v92, v93
    v_cvt_pk_bf16_f32 v87, v94, v95
    v_cndmask_b32 v86, v13, v86, vcc
    v_cndmask_b32 v87, 0, v87, vcc
    buffer_store_dwordx4 v[80:83], v1, s[32:35], s69 offen offset:0 sc1
    buffer_store_dwordx4 v[84:87], v1, s[32:35], s69 offen offset:1024 sc1
    v_pk_mul_f32 v[128:129], v[128:129], s[4:5]
    v_pk_mul_f32 v[130:131], v[130:131], s[4:5]
    v_pk_mul_f32 v[132:133], v[132:133], s[4:5]
    v_pk_mul_f32 v[134:135], v[134:135], s[4:5]
    v_pk_mul_f32 v[136:137], v[136:137], s[4:5]
    v_pk_mul_f32 v[138:139], v[138:139], s[4:5]
    v_pk_mul_f32 v[140:141], v[140:141], s[4:5]
    v_pk_mul_f32 v[142:143], v[142:143], s[4:5]
    v_cvt_pk_bf16_f32 v128, v128, v129
    v_cvt_pk_bf16_f32 v129, v130, v131
    v_cvt_pk_bf16_f32 v130, v132, v133
    v_cvt_pk_bf16_f32 v131, v134, v135
    v_cvt_pk_bf16_f32 v132, v136, v137
    v_cvt_pk_bf16_f32 v133, v138, v139
    v_cvt_pk_bf16_f32 v134, v140, v141
    v_cvt_pk_bf16_f32 v135, v142, v143
    v_cndmask_b32 v134, v13, v134, vcc
    v_cndmask_b32 v135, 0, v135, vcc
    buffer_store_dwordx4 v[128:131], v1, s[32:35], s69 offen offset:2048 sc1
    buffer_store_dwordx4 v[132:135], v1, s[32:35], s69 offen offset:3072 sc1
    s_branch L1_D_6
L1_N_5:
    v_cvt_pk_bf16_f32 v80, v80, v81
    v_cvt_pk_bf16_f32 v81, v82, v83
    v_cvt_pk_bf16_f32 v82, v84, v85
    v_cvt_pk_bf16_f32 v83, v86, v87
    v_cvt_pk_bf16_f32 v84, v88, v89
    v_cvt_pk_bf16_f32 v85, v90, v91
    v_cvt_pk_bf16_f32 v86, v92, v93
    v_cvt_pk_bf16_f32 v87, v94, v95
    v_cndmask_b32 v80, v12, v80, s[6:7]
    v_cndmask_b32 v81, v12, v81, s[6:7]
    v_cndmask_b32 v82, v12, v82, s[6:7]
    v_cndmask_b32 v83, v12, v83, s[6:7]
    v_cndmask_b32 v84, v12, v84, s[6:7]
    v_cndmask_b32 v85, v12, v85, s[6:7]
    v_cndmask_b32 v86, v12, v86, s[6:7]
    v_cndmask_b32 v87, v12, v87, s[6:7]
    buffer_store_dwordx4 v[80:83], v1, s[32:35], s69 offen offset:0 sc1
    buffer_store_dwordx4 v[84:87], v1, s[32:35], s69 offen offset:1024 sc1
    v_cvt_pk_bf16_f32 v128, v128, v129
    v_cvt_pk_bf16_f32 v129, v130, v131
    v_cvt_pk_bf16_f32 v130, v132, v133
    v_cvt_pk_bf16_f32 v131, v134, v135
    v_cvt_pk_bf16_f32 v132, v136, v137
    v_cvt_pk_bf16_f32 v133, v138, v139
    v_cvt_pk_bf16_f32 v134, v140, v141
    v_cvt_pk_bf16_f32 v135, v142, v143
    v_cndmask_b32 v128, v12, v128, s[6:7]
    v_cndmask_b32 v129, v12, v129, s[6:7]
    v_cndmask_b32 v130, v12, v130, s[6:7]
    v_cndmask_b32 v131, v12, v131, s[6:7]
    v_cndmask_b32 v132, v12, v132, s[6:7]
    v_cndmask_b32 v133, v12, v133, s[6:7]
    v_cndmask_b32 v134, v12, v134, s[6:7]
    v_cndmask_b32 v135, v12, v135, s[6:7]
    buffer_store_dwordx4 v[128:131], v1, s[32:35], s69 offen offset:2048 sc1
    buffer_store_dwordx4 v[132:135], v1, s[32:35], s69 offen offset:3072 sc1
L1_D_6:
    s_add_u32 s65, s71, 2
    s_lshr_b32 s66, s65, 4
    s_and_b32 s65, s65, 15
    s_lshl_b32 s65, s65, 17
    s_lshl_b32 s67, s66, 21
    s_add_u32 s65, s65, s67
    s_lshl_b32 s67, s68, 11
    s_add_u32 s69, s65, s67
    s_cmp_eq_u32 s66, 2
    s_cbranch_scc1 L1_N_7
    s_cmp_eq_u32 s66, 0
    s_cselect_b32 s4, 0x3e8b97f6, 1.0
    s_cselect_b32 s67, 0x3f80, 0
    s_mov_b32 s5, s4
    v_mov_b32 v13, s67
    v_pk_mul_f32 v[96:97], v[96:97], s[4:5]
    v_pk_mul_f32 v[98:99], v[98:99], s[4:5]
    v_pk_mul_f32 v[100:101], v[100:101], s[4:5]
    v_pk_mul_f32 v[102:103], v[102:103], s[4:5]
    v_pk_mul_f32 v[104:105], v[104:105], s[4:5]
    v_pk_mul_f32 v[106:107], v[106:107], s[4:5]
    v_pk_mul_f32 v[108:109], v[108:109], s[4:5]
    v_pk_mul_f32 v[110:111], v[110:111], s[4:5]
    v_cvt_pk_bf16_f32 v96, v96, v97
    v_cvt_pk_bf16_f32 v97, v98, v99
    v_cvt_pk_bf16_f32 v98, v100, v101
    v_cvt_pk_bf16_f32 v99, v102, v103
    v_cvt_pk_bf16_f32 v100, v104, v105
    v_cvt_pk_bf16_f32 v101, v106, v107
    v_cvt_pk_bf16_f32 v102, v108, v109
    v_cvt_pk_bf16_f32 v103, v110, v111
    v_cndmask_b32 v102, v13, v102, vcc
    v_cndmask_b32 v103, 0, v103, vcc
    buffer_store_dwordx4 v[96:99], v1, s[32:35], s69 offen offset:0 sc1
    buffer_store_dwordx4 v[100:103], v1, s[32:35], s69 offen offset:1024 sc1
    v_pk_mul_f32 v[144:145], v[144:145], s[4:5]
    v_pk_mul_f32 v[146:147], v[146:147], s[4:5]
    v_pk_mul_f32 v[148:149], v[148:149], s[4:5]
    v_pk_mul_f32 v[150:151], v[150:151], s[4:5]
    v_pk_mul_f32 v[152:153], v[152:153], s[4:5]
    v_pk_mul_f32 v[154:155], v[154:155], s[4:5]
    v_pk_mul_f32 v[156:157], v[156:157], s[4:5]
    v_pk_mul_f32 v[158:159], v[158:159], s[4:5]
    v_cvt_pk_bf16_f32 v144, v144, v145
    v_cvt_pk_bf16_f32 v145, v146, v147
    v_cvt_pk_bf16_f32 v146, v148, v149
    v_cvt_pk_bf16_f32 v147, v150, v151
    v_cvt_pk_bf16_f32 v148, v152, v153
    v_cvt_pk_bf16_f32 v149, v154, v155
    v_cvt_pk_bf16_f32 v150, v156, v157
    v_cvt_pk_bf16_f32 v151, v158, v159
    v_cndmask_b32 v150, v13, v150, vcc
    v_cndmask_b32 v151, 0, v151, vcc
    buffer_store_dwordx4 v[144:147], v1, s[32:35], s69 offen offset:2048 sc1
    buffer_store_dwordx4 v[148:151], v1, s[32:35], s69 offen offset:3072 sc1
    s_branch L1_D_8
L1_N_7:
    v_cvt_pk_bf16_f32 v96, v96, v97
    v_cvt_pk_bf16_f32 v97, v98, v99
    v_cvt_pk_bf16_f32 v98, v100, v101
    v_cvt_pk_bf16_f32 v99, v102, v103
    v_cvt_pk_bf16_f32 v100, v104, v105
    v_cvt_pk_bf16_f32 v101, v106, v107
    v_cvt_pk_bf16_f32 v102, v108, v109
    v_cvt_pk_bf16_f32 v103, v110, v111
    v_cndmask_b32 v96, v12, v96, s[6:7]
    v_cndmask_b32 v97, v12, v97, s[6:7]
    v_cndmask_b32 v98, v12, v98, s[6:7]
    v_cndmask_b32 v99, v12, v99, s[6:7]
    v_cndmask_b32 v100, v12, v100, s[6:7]
    v_cndmask_b32 v101, v12, v101, s[6:7]
    v_cndmask_b32 v102, v12, v102, s[6:7]
    v_cndmask_b32 v103, v12, v103, s[6:7]
    buffer_store_dwordx4 v[96:99], v1, s[32:35], s69 offen offset:0 sc1
    buffer_store_dwordx4 v[100:103], v1, s[32:35], s69 offen offset:1024 sc1
    v_cvt_pk_bf16_f32 v144, v144, v145
    v_cvt_pk_bf16_f32 v145, v146, v147
    v_cvt_pk_bf16_f32 v146, v148, v149
    v_cvt_pk_bf16_f32 v147, v150, v151
    v_cvt_pk_bf16_f32 v148, v152, v153
    v_cvt_pk_bf16_f32 v149, v154, v155
    v_cvt_pk_bf16_f32 v150, v156, v157
    v_cvt_pk_bf16_f32 v151, v158, v159
    v_cndmask_b32 v144, v12, v144, s[6:7]
    v_cndmask_b32 v145, v12, v145, s[6:7]
    v_cndmask_b32 v146, v12, v146, s[6:7]
    v_cndmask_b32 v147, v12, v147, s[6:7]
    v_cndmask_b32 v148, v12, v148, s[6:7]
    v_cndmask_b32 v149, v12, v149, s[6:7]
    v_cndmask_b32 v150, v12, v150, s[6:7]
    v_cndmask_b32 v151, v12, v151, s[6:7]
    buffer_store_dwordx4 v[144:147], v1, s[32:35], s69 offen offset:2048 sc1
    buffer_store_dwordx4 v[148:151], v1, s[32:35], s69 offen offset:3072 sc1
L1_D_8:
    s_waitcnt vmcnt(0)
    s_barrier
    v_readfirstlane_b32 s58, v9
    s_mov_b32 s74, 0
    s_nop 2
    s_cmp_lg_u32 s58, 0
    s_cbranch_scc1 L_nonce_9_x
L_nonce_9:
    v_lshlrev_b32 v10, 2, v0
    buffer_load_dword v9, v10, s[44:47], 0 offen sc1
    s_waitcnt vmcnt(0)
    v_readfirstlane_b32 s58, v9
    s_add_u32 s74, s74, 1
    s_cmp_gt_u32 s74, 400000
    s_cbranch_scc1 L_nonce_9_x
    s_cmp_eq_u32 s58, 0
    s_cbranch_scc1 L_nonce_9
L_nonce_9_x:
    s_cmp_eq_u32 s54, 0
    s_cbranch_scc0 L2_start
    s_lshl_b32 s65, s57, 4
    s_add_u32 s65, s65, s56
    s_lshl_b32 s65, s65, 7
    s_add_u32 s65, s65, 0xd10000
    v_mov_b32 v10, 0
    v_mov_b32 v11, s58
    s_mov_b64 exec, 1
    buffer_store_dword v11, v10, s[32:35], s65 offen sc1
    s_mov_b64 exec, -1
L2_start:
    s_and_b32 s65, s53, 1
    s_lshl_b32 s66, s52, 1
    s_add_u32 s71, s65, s66
    s_lshr_b32 s72, s53, 1
    s_lshl_b32 s65, s72, 2
    s_add_u32 s73, s65, s54
    s_cmp_eq_u32 s54, 0
    s_cbranch_scc0 L2_notw0
    v_add_u32 v3, 2, v0
    v_mul_u32_u24 v4, 43, v3
    v_lshrrev_b32 v4, 7, v4
    v_mul_u32_u24 v5, 3, v4
    v_sub_u32 v5, v3, v5
    v_add_u32 v5, s72, v5
    v_subrev_u32 v5, 2, v5
    v_max_i32 v5, 0, v5
    v_min_i32 v5, 15, v5
    v_lshlrev_b32 v4, 4, v4
    v_add_u32 v4, s71, v4
    v_mul_u32_u24 v4, 43, v4
    v_lshrrev_b32 v4, 8, v4
    v_min_u32 v4, 7, v4
    v_lshl_add_u32 v3, v4, 4, v5
    v_lshlrev_b32 v3, 7, v3
    s_mov_b32 s65, 0xd10000
    s_mov_b32 s74, 0
L_poll_10:
    buffer_load_dword v4, v3, s[32:35], s65 offen sc1
    s_waitcnt vmcnt(0)
    v_cmp_eq_u32 vcc, s58, v4
    s_add_u32 s74, s74, 1
    s_cmp_gt_u32 s74, 400000
    s_cbranch_scc1 L_polled_11
    s_and_b32 s70, vcc_lo, 0x7f
    s_cmp_eq_u32 s70, 0x7f
    s_cbranch_scc1 L_polled_11
    s_sleep 2
    s_branch L_poll_10
L_polled_11:
    s_branch L2_polled
L2_notw0:
L2_polled:
    s_barrier
    s_lshl_b32 s69, s71, 17
    s_lshl_b32 s65, s73, 11
    s_add_u32 s65, s65, s69
    s_add_u32 s65, s65, 0x0
    s_mul_i32 s66, s54, 3
    s_lshl_b32 s67, s66, 11
    s_lshl_b32 s68, s72, 2
    s_add_u32 s68, s68, s66
    s_sub_i32 s68, s68, 8
    s_max_i32 s68, s68, 0
    s_lshl_b32 s68, s68, 11
    s_add_u32 s13, s68, s69
    s_lshl_b32 s68, s72, 2
    s_add_u32 s68, s68, s66
    s_sub_i32 s68, s68, 7
    s_max_i32 s68, s68, 0
    s_lshl_b32 s68, s68, 11
    s_add_u32 s16, s68, s69
    s_lshl_b32 s68, s72, 2
    s_add_u32 s68, s68, s66
    s_sub_i32 s68, s68, 6
    s_max_i32 s68, s68, 0
    s_lshl_b32 s68, s68, 11
    s_add_u32 s17, s68, s69
    s_add_u32 s70, s67, 114688
    s_mov_b32 m0, s70
    s_add_u32 s70, s13, 0x200000
    buffer_load_dwordx4 v1, s[32:35], s70 offen sc1 lds
    buffer_load_dwordx4 v1, s[32:35], s70 offen offset:1024 sc1 lds
    s_add_u32 s70, s67, 116736
    s_mov_b32 m0, s70
    s_add_u32 s70, s16, 0x200000
    buffer_load_dwordx4 v1, s[32:35], s70 offen sc1 lds
    buffer_load_dwordx4 v1, s[32:35], s70 offen offset:1024 sc1 lds
    s_add_u32 s70, s67, 118784
    s_mov_b32 m0, s70
    s_add_u32 s70, s17, 0x200000
    buffer_load_dwordx4 v1, s[32:35], s70 offen sc1 lds
    buffer_load_dwordx4 v1, s[32:35], s70 offen offset:1024 sc1 lds
    buffer_load_dwordx4 v[4:7], v1, s[32:35], s65 offen sc1
    buffer_load_dwordx4 v[8:11], v1, s[32:35], s65 offen offset:1024 sc1
    s_add_u32 s70, s67, 139264
    s_mov_b32 m0, s70
    s_add_u32 s70, s13, 0x400000
    buffer_load_dwordx4 v1, s[32:35], s70 offen sc1 lds
    buffer_load_dwordx4 v1, s[32:35], s70 offen offset:1024 sc1 lds
    s_add_u32 s70, s67, 141312
    s_mov_b32 m0, s70
    s_add_u32 s70, s16, 0x400000
    buffer_load_dwordx4 v1, s[32:35], s70 offen sc1 lds
    buffer_load_dwordx4 v1, s[32:35], s70 offen offset:1024 sc1 lds
    s_add_u32 s70, s67, 143360
    s_mov_b32 m0, s70
    s_add_u32 s70, s17, 0x400000
    buffer_load_dwordx4 v1, s[32:35], s70 offen sc1 lds
    buffer_load_dwordx4 v1, s[32:35], s70 offen offset:1024 sc1 lds
    v_and_b32 v3, 31, v0
    v_lshrrev_b32 v12, 5, v0
    v_lshlrev_b32 v12, 2, v12
    v_sub_u32 v3, v3, v12
    v_cmp_ge_i32 s[76:77], v3, 0
    v_cmp_ge_i32 s[78:79], v3, 1
    v_cmp_ge_i32 s[80:81], v3, 2
    v_cmp_ge_i32 s[82:83], v3, 3
    v_cmp_ge_i32 s[84:85], v3, 8
    v_cmp_ge_i32 s[86:87], v3, 9
    v_cmp_ge_i32 s[88:89], v3, 10
    v_cmp_ge_i32 s[90:91], v3, 11
    v_cmp_ge_i32 s[92:93], v3, 16
    v_cmp_ge_i32 s[94:95], v3, 17
    v_cmp_ge_i32 s[96:97], v3, 18
    v_cmp_ge_i32 s[98:99], v3, 19
    v_cmp_ge_i32 s[100:101], v3, 24
    v_cmp_ge_i32 s[4:5], v3, 25
    v_cmp_ge_i32 s[6:7], v3, 26
    v_cmp_ge_i32 s[8:9], v3, 27
    v_mov_b32 v13, 0xffff
    v_cndmask_b32 v12, 0, v13, s[76:77]
    v_cndmask_b32 v196, v12, -1, s[78:79]
    v_cndmask_b32 v12, 0, v13, s[80:81]
    v_cndmask_b32 v197, v12, -1, s[82:83]
    v_cndmask_b32 v12, 0, v13, s[84:85]
    v_cndmask_b32 v198, v12, -1, s[86:87]
    v_cndmask_b32 v12, 0, v13, s[88:89]
    v_cndmask_b32 v199, v12, -1, s[90:91]
    v_cndmask_b32 v12, 0, v13, s[92:93]
    v_cndmask_b32 v200, v12, -1, s[94:95]
    v_cndmask_b32 v12, 0, v13, s[96:97]
    v_cndmask_b32 v201, v12, -1, s[98:99]
    v_cndmask_b32 v12, 0, v13, s[100:101]
    v_cndmask_b32 v202, v12, -1, s[4:5]
    v_cndmask_b32 v12, 0, v13, s[6:7]
    v_cndmask_b32 v203, v12, -1, s[8:9]
    s_lshl_b32 s65, s54, 11
    s_add_u32 s65, s65, 114688
    v_add_u32 v3, s65, v1
    s_waitcnt vmcnt(6)
    s_cmp_lt_u32 s72, 2
    s_cbranch_scc0 L2_nopatch
    v_mov_b32 v13, 0xf149
    s_mul_i32 s66, s54, 3
    s_lshl_b32 s67, s66, 11
    s_add_u32 s67, s67, 115720
    v_add_u32 v12, s67, v1
    s_mov_b32 exec_lo, 0
    s_lshl_b32 s68, s72, 2
    s_add_u32 s68, s68, s66
    s_add_u32 s68, s68, 0
    s_cmp_lt_u32 s68, 8
    s_cbranch_scc0 L2_patched
    ds_write_b32 v12, v13 offset:0
    s_lshl_b32 s68, s72, 2
    s_add_u32 s68, s68, s66
    s_add_u32 s68, s68, 1
    s_cmp_lt_u32 s68, 8
    s_cbranch_scc0 L2_patched
    ds_write_b32 v12, v13 offset:2048
    s_lshl_b32 s68, s72, 2
    s_add_u32 s68, s68, s66
    s_add_u32 s68, s68, 2
    s_cmp_lt_u32 s68, 8
    s_cbranch_scc0 L2_patched
    ds_write_b32 v12, v13 offset:4096
L2_patched:
    s_mov_b32 exec_lo, -1
    s_waitcnt lgkmcnt(0)
L2_nopatch:
    s_barrier
    ds_read_b128 v[16:19], v3 offset:16384
    ds_read_b128 v[20:23], v3 offset:17408
    ds_read_b128 v[24:27], v3 offset:0
    ds_read_b128 v[28:31], v3 offset:1024
    s_waitcnt lgkmcnt(2)
    v_mfma_f32_32x32x16_bf16 v[160:175], v[16:19], v[4:7], 0
    v_mfma_f32_32x32x16_bf16 v[160:175], v[20:23], v[8:11], v[160:175]
    ds_read_b128 v[16:19], v3 offset:2048
    ds_read_b128 v[20:23], v3 offset:3072
    s_waitcnt lgkmcnt(2)
    v_mfma_f32_32x32x16_bf16 v[32:47], v[24:27], v[4:7], 0
    v_mfma_f32_32x32x16_bf16 v[32:47], v[28:31], v[8:11], v[32:47]
    ds_read_b128 v[24:27], v3 offset:4096
    ds_read_b128 v[28:31], v3 offset:5120
    s_waitcnt lgkmcnt(2)
    v_mfma_f32_32x32x16_bf16 v[48:63], v[16:19], v[4:7], 0
    v_mfma_f32_32x32x16_bf16 v[48:63], v[20:23], v[8:11], v[48:63]
    ds_read_b128 v[16:19], v3 offset:6144
    ds_read_b128 v[20:23], v3 offset:7168
    s_waitcnt lgkmcnt(2)
    v_mfma_f32_32x32x16_bf16 v[64:79], v[24:27], v[4:7], 0
    v_mfma_f32_32x32x16_bf16 v[64:79], v[28:31], v[8:11], v[64:79]
    ds_read_b128 v[24:27], v3 offset:8192
    ds_read_b128 v[28:31], v3 offset:9216
    s_waitcnt lgkmcnt(2)
    v_mfma_f32_32x32x16_bf16 v[80:95], v[16:19], v[4:7], 0
    v_cndmask_b32 v32, v32, v160, s[76:77]
    v_cndmask_b32 v33, v33, v161, s[78:79]
    v_cndmask_b32 v34, v34, v162, s[80:81]
    v_cndmask_b32 v35, v35, v163, s[82:83]
    v_cndmask_b32 v36, v36, v164, s[84:85]
    v_cndmask_b32 v37, v37, v165, s[86:87]
    v_cndmask_b32 v38, v38, v166, s[88:89]
    v_mfma_f32_32x32x16_bf16 v[80:95], v[20:23], v[8:11], v[80:95]
    v_cndmask_b32 v39, v39, v167, s[90:91]
    v_cndmask_b32 v40, v40, v168, s[92:93]
    v_cndmask_b32 v41, v41, v169, s[94:95]
    v_cndmask_b32 v42, v42, v170, s[96:97]
    v_cndmask_b32 v43, v43, v171, s[98:99]
    v_cndmask_b32 v44, v44, v172, s[100:101]
    v_cndmask_b32 v45, v45, v173, s[4:5]
    ds_read_b128 v[16:19], v3 offset:10240
    ds_read_b128 v[20:23], v3 offset:11264
    s_waitcnt lgkmcnt(2)
    v_mfma_f32_32x32x16_bf16 v[96:111], v[24:27], v[4:7], 0
    v_cndmask_b32 v46, v46, v174, s[6:7]
    v_cndmask_b32 v47, v47, v175, s[8:9]
    v_max3_f32 v192, v32, v33, v34
    v_max3_f32 v193, v36, v37, v38
    v_max3_f32 v194, v40, v41, v42
    v_max3_f32 v195, v44, v45, v46
    v_max3_f32 v192, v192, v35, v39
    v_mfma_f32_32x32x16_bf16 v[96:111], v[28:31], v[8:11], v[96:111]
    v_max3_f32 v194, v194, v43, v47
    v_max3_f32 v192, v192, v48, v49
    v_max3_f32 v193, v193, v50, v51
    v_max3_f32 v194, v194, v52, v53
    v_max3_f32 v195, v195, v54, v55
    v_max3_f32 v192, v192, v56, v57
    v_max3_f32 v193, v193, v58, v59
    ds_read_b128 v[24:27], v3 offset:12288
    ds_read_b128 v[28:31], v3 offset:13312
    s_waitcnt lgkmcnt(2)
    v_mfma_f32_32x32x16_bf16 v[112:127], v[16:19], v[4:7], 0
    v_max3_f32 v194, v194, v60, v61
    v_max3_f32 v195, v195, v62, v63
    v_max3_f32 v192, v192, v64, v65
    v_max3_f32 v193, v193, v66, v67
    v_max3_f32 v194, v194, v68, v69
    v_max3_f32 v195, v195, v70, v71
    v_max3_f32 v192, v192, v72, v73
    v_mfma_f32_32x32x16_bf16 v[112:127], v[20:23], v[8:11], v[112:127]
    v_max3_f32 v193, v193, v74, v75
    v_max3_f32 v194, v194, v76, v77
    v_max3_f32 v195, v195, v78, v79
    ds_read_b128 v[16:19], v3 offset:14336
    ds_read_b128 v[20:23], v3 offset:15360
    s_waitcnt lgkmcnt(2)
    v_mfma_f32_32x32x16_bf16 v[128:143], v[24:27], v[4:7], 0
    v_max3_f32 v192, v192, v80, v81
    v_max3_f32 v193, v193, v82, v83
    v_max3_f32 v194, v194, v84, v85
    v_max3_f32 v195, v195, v86, v87
    v_max3_f32 v192, v192, v88, v89
    v_max3_f32 v193, v193, v90, v91
    v_max3_f32 v194, v194, v92, v93
    v_mfma_f32_32x32x16_bf16 v[128:143], v[28:31], v[8:11], v[128:143]
    v_max3_f32 v195, v195, v94, v95
    s_waitcnt lgkmcnt(0)
    v_mfma_f32_32x32x16_bf16 v[144:159], v[16:19], v[4:7], 0
    v_max3_f32 v192, v192, v96, v97
    v_max3_f32 v193, v193, v98, v99
    v_max3_f32 v194, v194, v100, v101
    v_max3_f32 v195, v195, v102, v103
    v_max3_f32 v192, v192, v104, v105
    v_max3_f32 v193, v193, v106, v107
    v_max3_f32 v194, v194, v108, v109
    v_mfma_f32_32x32x16_bf16 v[144:159], v[20:23], v[8:11], v[144:159]
    v_max3_f32 v195, v195, v110, v111
    s_waitcnt vmcnt(0)
    s_barrier
    ds_read_b128 v[24:27], v3 offset:24576
    ds_read_b128 v[28:31], v3 offset:25600
    ds_read_b128 v[16:19], v3 offset:40960
    ds_read_b128 v[20:23], v3 offset:41984
    s_nop 7
    v_max3_f32 v192, v192, v112, v113
    v_max3_f32 v193, v193, v114, v115
    v_max3_f32 v194, v194, v116, v117
    v_max3_f32 v195, v195, v118, v119
    v_max3_f32 v192, v192, v120, v121
    v_max3_f32 v193, v193, v122, v123
    v_max3_f32 v194, v194, v124, v125
    v_max3_f32 v195, v195, v126, v127
    v_max3_f32 v192, v192, v128, v129
    v_max3_f32 v193, v193, v130, v131
    v_max3_f32 v194, v194, v132, v133
    v_max3_f32 v195, v195, v134, v135
    v_max3_f32 v192, v192, v136, v137
    v_max3_f32 v193, v193, v138, v139
    v_max3_f32 v194, v194, v140, v141
    v_max3_f32 v195, v195, v142, v143
    v_max3_f32 v192, v192, v144, v145
    v_max3_f32 v193, v193, v146, v147
    v_max3_f32 v194, v194, v148, v149
    v_max3_f32 v195, v195, v150, v151
    v_max3_f32 v192, v192, v152, v153
    v_max3_f32 v193, v193, v154, v155
    v_max3_f32 v194, v194, v156, v157
    v_max3_f32 v195, v195, v158, v159
    v_max3_f32 v192, v192, v193, v194
    v_max_f32 v192, v192, v195
    v_mov_b32 v193, v192
    s_nop 1
    v_permlane32_swap_b32 v192, v193
    v_max_f32 v192, v192, v193
    v_sub_f32 v192, 0, v192
    v_mov_b32 v193, v192
    v_pk_add_f32 v[32:33], v[32:33], v[192:193]
    v_pk_add_f32 v[34:35], v[34:35], v[192:193]
    v_pk_add_f32 v[36:37], v[36:37], v[192:193]
    v_pk_add_f32 v[38:39], v[38:39], v[192:193]
    v_pk_add_f32 v[40:41], v[40:41], v[192:193]
    v_pk_add_f32 v[42:43], v[42:43], v[192:193]
    v_pk_add_f32 v[44:45], v[44:45], v[192:193]
    v_pk_add_f32 v[46:47], v[46:47], v[192:193]
    v_exp_f32 v32, v32
    v_exp_f32 v33, v33
    v_exp_f32 v34, v34
    v_exp_f32 v35, v35
    v_exp_f32 v36, v36
    v_exp_f32 v37, v37
    v_exp_f32 v38, v38
    v_exp_f32 v39, v39
    v_exp_f32 v40, v40
    v_exp_f32 v41, v41
    v_exp_f32 v42, v42
    v_exp_f32 v43, v43
    v_exp_f32 v44, v44
    v_exp_f32 v45, v45
    v_exp_f32 v46, v46
    v_exp_f32 v47, v47
    v_cvt_pk_bf16_f32 v32, v32, v33
    v_cvt_pk_bf16_f32 v33, v34, v35
    v_cvt_pk_bf16_f32 v34, v36, v37
    v_cvt_pk_bf16_f32 v35, v38, v39
    v_cvt_pk_bf16_f32 v36, v40, v41
    v_cvt_pk_bf16_f32 v37, v42, v43
    v_cvt_pk_bf16_f32 v38, v44, v45
    v_cvt_pk_bf16_f32 v39, v46, v47
    v_and_b32 v160, v196, v32
    v_and_b32 v161, v197, v33
    v_and_b32 v162, v198, v34
    v_and_b32 v163, v199, v35
    v_and_b32 v164, v200, v36
    v_and_b32 v165, v201, v37
    v_and_b32 v166, v202, v38
    v_and_b32 v167, v203, v39
    v_xor_b32 v32, v160, v32
    v_xor_b32 v33, v161, v33
    v_xor_b32 v34, v162, v34
    v_xor_b32 v35, v163, v35
    v_xor_b32 v36, v164, v36
    v_xor_b32 v37, v165, v37
    v_xor_b32 v38, v166, v38
    v_xor_b32 v39, v167, v39
    v_pk_add_f32 v[48:49], v[48:49], v[192:193]
    v_pk_add_f32 v[50:51], v[50:51], v[192:193]
    v_pk_add_f32 v[52:53], v[52:53], v[192:193]
    v_pk_add_f32 v[54:55], v[54:55], v[192:193]
    v_pk_add_f32 v[56:57], v[56:57], v[192:193]
    v_pk_add_f32 v[58:59], v[58:59], v[192:193]
    v_pk_add_f32 v[60:61], v[60:61], v[192:193]
    v_pk_add_f32 v[62:63], v[62:63], v[192:193]
    s_waitcnt lgkmcnt(2)
    v_mfma_f32_32x32x16_bf16 v[176:191], v[24:27], v[32:35], 0
    v_exp_f32 v48, v48
    v_exp_f32 v49, v49
    v_exp_f32 v50, v50
    v_exp_f32 v51, v51
    v_exp_f32 v52, v52
    v_exp_f32 v53, v53
    v_exp_f32 v54, v54
    v_exp_f32 v55, v55
    v_mfma_f32_32x32x16_bf16 v[176:191], v[28:31], v[36:39], v[176:191]
    ds_read_b128 v[24:27], v3 offset:26624
    ds_read_b128 v[28:31], v3 offset:27648
    v_exp_f32 v56, v56
    v_exp_f32 v57, v57
    v_exp_f32 v58, v58
    v_exp_f32 v59, v59
    v_exp_f32 v60, v60
    v_exp_f32 v61, v61
    v_exp_f32 v62, v62
    v_exp_f32 v63, v63
    s_waitcnt lgkmcnt(2)
    v_mfma_f32_32x32x16_bf16 v[176:191], v[16:19], v[160:163], v[176:191]
    v_cvt_pk_bf16_f32 v48, v48, v49
    v_cvt_pk_bf16_f32 v49, v50, v51
    v_cvt_pk_bf16_f32 v50, v52, v53
    v_cvt_pk_bf16_f32 v51, v54, v55
    v_cvt_pk_bf16_f32 v52, v56, v57
    v_cvt_pk_bf16_f32 v53, v58, v59
    v_cvt_pk_bf16_f32 v54, v60, v61
    v_cvt_pk_bf16_f32 v55, v62, v63
    v_mfma_f32_32x32x16_bf16 v[176:191], v[20:23], v[164:167], v[176:191]
    ds_read_b128 v[16:19], v3 offset:28672
    ds_read_b128 v[20:23], v3 offset:29696
    v_pk_add_f32 v[64:65], v[64:65], v[192:193]
    v_pk_add_f32 v[66:67], v[66:67], v[192:193]
    v_pk_add_f32 v[68:69], v[68:69], v[192:193]
    v_pk_add_f32 v[70:71], v[70:71], v[192:193]
    v_pk_add_f32 v[72:73], v[72:73], v[192:193]
    v_pk_add_f32 v[74:75], v[74:75], v[192:193]
    v_pk_add_f32 v[76:77], v[76:77], v[192:193]
    v_pk_add_f32 v[78:79], v[78:79], v[192:193]
    v_exp_f32 v64, v64
    v_exp_f32 v65, v65
    v_exp_f32 v66, v66
    v_exp_f32 v67, v67
    v_exp_f32 v68, v68
    v_exp_f32 v69, v69
    v_exp_f32 v70, v70
    v_exp_f32 v71, v71
    s_waitcnt lgkmcnt(2)
    v_mfma_f32_32x32x16_bf16 v[176:191], v[24:27], v[48:51], v[176:191]
    v_exp_f32 v72, v72
    v_exp_f32 v73, v73
    v_exp_f32 v74, v74
    v_exp_f32 v75, v75
    v_exp_f32 v76, v76
    v_exp_f32 v77, v77
    v_exp_f32 v78, v78
    v_exp_f32 v79, v79
    v_cvt_pk_bf16_f32 v64, v64, v65
    v_cvt_pk_bf16_f32 v65, v66, v67
    v_cvt_pk_bf16_f32 v66, v68, v69
    v_cvt_pk_bf16_f32 v67, v70, v71
    v_cvt_pk_bf16_f32 v68, v72, v73
    v_cvt_pk_bf16_f32 v69, v74, v75
    v_cvt_pk_bf16_f32 v70, v76, v77
    v_cvt_pk_bf16_f32 v71, v78, v79
    v_mfma_f32_32x32x16_bf16 v[176:191], v[28:31], v[52:55], v[176:191]
    ds_read_b128 v[24:27], v3 offset:30720
    ds_read_b128 v[28:31], v3 offset:31744
    v_pk_add_f32 v[80:81], v[80:81], v[192:193]
    v_pk_add_f32 v[82:83], v[82:83], v[192:193]
    v_pk_add_f32 v[84:85], v[84:85], v[192:193]
    v_pk_add_f32 v[86:87], v[86:87], v[192:193]
    v_pk_add_f32 v[88:89], v[88:89], v[192:193]
    v_pk_add_f32 v[90:91], v[90:91], v[192:193]
    v_pk_add_f32 v[92:93], v[92:93], v[192:193]
    v_pk_add_f32 v[94:95], v[94:95], v[192:193]
    v_exp_f32 v80, v80
    v_exp_f32 v81, v81
    v_exp_f32 v82, v82
    v_exp_f32 v83, v83
    v_exp_f32 v84, v84
    v_exp_f32 v85, v85
    v_exp_f32 v86, v86
    v_exp_f32 v87, v87
    s_waitcnt lgkmcnt(2)
    v_mfma_f32_32x32x16_bf16 v[176:191], v[16:19], v[64:67], v[176:191]
    v_exp_f32 v88, v88
    v_exp_f32 v89, v89
    v_exp_f32 v90, v90
    v_exp_f32 v91, v91
    v_exp_f32 v92, v92
    v_exp_f32 v93, v93
    v_exp_f32 v94, v94
    v_exp_f32 v95, v95
    v_cvt_pk_bf16_f32 v80, v80, v81
    v_cvt_pk_bf16_f32 v81, v82, v83
    v_cvt_pk_bf16_f32 v82, v84, v85
    v_cvt_pk_bf16_f32 v83, v86, v87
    v_cvt_pk_bf16_f32 v84, v88, v89
    v_cvt_pk_bf16_f32 v85, v90, v91
    v_cvt_pk_bf16_f32 v86, v92, v93
    v_cvt_pk_bf16_f32 v87, v94, v95
    v_mfma_f32_32x32x16_bf16 v[176:191], v[20:23], v[68:71], v[176:191]
    ds_read_b128 v[16:19], v3 offset:32768
    ds_read_b128 v[20:23], v3 offset:33792
    v_pk_add_f32 v[96:97], v[96:97], v[192:193]
    v_pk_add_f32 v[98:99], v[98:99], v[192:193]
    v_pk_add_f32 v[100:101], v[100:101], v[192:193]
    v_pk_add_f32 v[102:103], v[102:103], v[192:193]
    v_pk_add_f32 v[104:105], v[104:105], v[192:193]
    v_pk_add_f32 v[106:107], v[106:107], v[192:193]
    v_pk_add_f32 v[108:109], v[108:109], v[192:193]
    v_pk_add_f32 v[110:111], v[110:111], v[192:193]
    v_exp_f32 v96, v96
    v_exp_f32 v97, v97
    v_exp_f32 v98, v98
    v_exp_f32 v99, v99
    v_exp_f32 v100, v100
    v_exp_f32 v101, v101
    v_exp_f32 v102, v102
    v_exp_f32 v103, v103
    s_waitcnt lgkmcnt(2)
    v_mfma_f32_32x32x16_bf16 v[176:191], v[24:27], v[80:83], v[176:191]
    v_exp_f32 v104, v104
    v_exp_f32 v105, v105
    v_exp_f32 v106, v106
    v_exp_f32 v107, v107
    v_exp_f32 v108, v108
    v_exp_f32 v109, v109
    v_exp_f32 v110, v110
    v_exp_f32 v111, v111
    v_cvt_pk_bf16_f32 v96, v96, v97
    v_cvt_pk_bf16_f32 v97, v98, v99
    v_cvt_pk_bf16_f32 v98, v100, v101
    v_cvt_pk_bf16_f32 v99, v102, v103
    v_cvt_pk_bf16_f32 v100, v104, v105
    v_cvt_pk_bf16_f32 v101, v106, v107
    v_cvt_pk_bf16_f32 v102, v108, v109
    v_cvt_pk_bf16_f32 v103, v110, v111
    v_mfma_f32_32x32x16_bf16 v[176:191], v[28:31], v[84:87], v[176:191]
    ds_read_b128 v[24:27], v3 offset:34816
    ds_read_b128 v[28:31], v3 offset:35840
    v_pk_add_f32 v[112:113], v[112:113], v[192:193]
    v_pk_add_f32 v[114:115], v[114:115], v[192:193]
    v_pk_add_f32 v[116:117], v[116:117], v[192:193]
    v_pk_add_f32 v[118:119], v[118:119], v[192:193]
    v_pk_add_f32 v[120:121], v[120:121], v[192:193]
    v_pk_add_f32 v[122:123], v[122:123], v[192:193]
    v_pk_add_f32 v[124:125], v[124:125], v[192:193]
    v_pk_add_f32 v[126:127], v[126:127], v[192:193]
    v_exp_f32 v112, v112
    v_exp_f32 v113, v113
    v_exp_f32 v114, v114
    v_exp_f32 v115, v115
    v_exp_f32 v116, v116
    v_exp_f32 v117, v117
    v_exp_f32 v118, v118
    v_exp_f32 v119, v119
    s_waitcnt lgkmcnt(2)
    v_mfma_f32_32x32x16_bf16 v[176:191], v[16:19], v[96:99], v[176:191]
    v_exp_f32 v120, v120
    v_exp_f32 v121, v121
    v_exp_f32 v122, v122
    v_exp_f32 v123, v123
    v_exp_f32 v124, v124
    v_exp_f32 v125, v125
    v_exp_f32 v126, v126
    v_exp_f32 v127, v127
    v_cvt_pk_bf16_f32 v112, v112, v113
    v_cvt_pk_bf16_f32 v113, v114, v115
    v_cvt_pk_bf16_f32 v114, v116, v117
    v_cvt_pk_bf16_f32 v115, v118, v119
    v_cvt_pk_bf16_f32 v116, v120, v121
    v_cvt_pk_bf16_f32 v117, v122, v123
    v_cvt_pk_bf16_f32 v118, v124, v125
    v_cvt_pk_bf16_f32 v119, v126, v127
    v_mfma_f32_32x32x16_bf16 v[176:191], v[20:23], v[100:103], v[176:191]
    ds_read_b128 v[16:19], v3 offset:36864
    ds_read_b128 v[20:23], v3 offset:37888
    v_pk_add_f32 v[128:129], v[128:129], v[192:193]
    v_pk_add_f32 v[130:131], v[130:131], v[192:193]
    v_pk_add_f32 v[132:133], v[132:133], v[192:193]
    v_pk_add_f32 v[134:135], v[134:135], v[192:193]
    v_pk_add_f32 v[136:137], v[136:137], v[192:193]
    v_pk_add_f32 v[138:139], v[138:139], v[192:193]
    v_pk_add_f32 v[140:141], v[140:141], v[192:193]
    v_pk_add_f32 v[142:143], v[142:143], v[192:193]
    v_exp_f32 v128, v128
    v_exp_f32 v129, v129
    v_exp_f32 v130, v130
    v_exp_f32 v131, v131
    v_exp_f32 v132, v132
    v_exp_f32 v133, v133
    v_exp_f32 v134, v134
    v_exp_f32 v135, v135
    s_waitcnt lgkmcnt(2)
    v_mfma_f32_32x32x16_bf16 v[176:191], v[24:27], v[112:115], v[176:191]
    v_exp_f32 v136, v136
    v_exp_f32 v137, v137
    v_exp_f32 v138, v138
    v_exp_f32 v139, v139
    v_exp_f32 v140, v140
    v_exp_f32 v141, v141
    v_exp_f32 v142, v142
    v_exp_f32 v143, v143
    v_cvt_pk_bf16_f32 v128, v128, v129
    v_cvt_pk_bf16_f32 v129, v130, v131
    v_cvt_pk_bf16_f32 v130, v132, v133
    v_cvt_pk_bf16_f32 v131, v134, v135
    v_cvt_pk_bf16_f32 v132, v136, v137
    v_cvt_pk_bf16_f32 v133, v138, v139
    v_cvt_pk_bf16_f32 v134, v140, v141
    v_cvt_pk_bf16_f32 v135, v142, v143
    v_mfma_f32_32x32x16_bf16 v[176:191], v[28:31], v[116:119], v[176:191]
    ds_read_b128 v[24:27], v3 offset:38912
    ds_read_b128 v[28:31], v3 offset:39936
    v_pk_add_f32 v[144:145], v[144:145], v[192:193]
    v_pk_add_f32 v[146:147], v[146:147], v[192:193]
    v_pk_add_f32 v[148:149], v[148:149], v[192:193]
    v_pk_add_f32 v[150:151], v[150:151], v[192:193]
    v_pk_add_f32 v[152:153], v[152:153], v[192:193]
    v_pk_add_f32 v[154:155], v[154:155], v[192:193]
    v_pk_add_f32 v[156:157], v[156:157], v[192:193]
    v_pk_add_f32 v[158:159], v[158:159], v[192:193]
    v_exp_f32 v144, v144
    v_exp_f32 v145, v145
    v_exp_f32 v146, v146
    v_exp_f32 v147, v147
    v_exp_f32 v148, v148
    v_exp_f32 v149, v149
    v_exp_f32 v150, v150
    v_exp_f32 v151, v151
    s_waitcnt lgkmcnt(2)
    v_mfma_f32_32x32x16_bf16 v[176:191], v[16:19], v[128:131], v[176:191]
    v_exp_f32 v152, v152
    v_exp_f32 v153, v153
    v_exp_f32 v154, v154
    v_exp_f32 v155, v155
    v_exp_f32 v156, v156
    v_exp_f32 v157, v157
    v_exp_f32 v158, v158
    v_exp_f32 v159, v159
    v_cvt_pk_bf16_f32 v144, v144, v145
    v_cvt_pk_bf16_f32 v145, v146, v147
    v_cvt_pk_bf16_f32 v146, v148, v149
    v_cvt_pk_bf16_f32 v147, v150, v151
    v_cvt_pk_bf16_f32 v148, v152, v153
    v_cvt_pk_bf16_f32 v149, v154, v155
    v_cvt_pk_bf16_f32 v150, v156, v157
    v_cvt_pk_bf16_f32 v151, v158, v159
    v_mfma_f32_32x32x16_bf16 v[176:191], v[20:23], v[132:135], v[176:191]
    s_waitcnt lgkmcnt(0)
    v_mfma_f32_32x32x16_bf16 v[176:191], v[24:27], v[144:147], v[176:191]
    v_mfma_f32_32x32x16_bf16 v[176:191], v[28:31], v[148:151], v[176:191]
    v_cmp_gt_u32 vcc, 32, v0
    s_nop 11
    v_mov_b32 v192, v188
    v_mov_b32 v193, v188
    s_nop 1
    v_permlane32_swap_b32 v192, v193
    v_rcp_f32 v193, v193
    s_nop 0
    v_mov_b32 v192, v193
    v_pk_mul_f32 v[176:177], v[176:177], v[192:193]
    v_pk_mul_f32 v[178:179], v[178:179], v[192:193]
    v_pk_mul_f32 v[180:181], v[180:181], v[192:193]
    v_pk_mul_f32 v[182:183], v[182:183], v[192:193]
    v_pk_mul_f32 v[184:185], v[184:185], v[192:193]
    v_pk_mul_f32 v[186:187], v[186:187], v[192:193]
    v_pk_mul_f32 v[188:189], v[188:189], v[192:193]
    v_pk_mul_f32 v[190:191], v[190:191], v[192:193]
    v_cvt_pk_bf16_f32 v176, v176, v177
    v_cvt_pk_bf16_f32 v177, v178, v179
    v_cvt_pk_bf16_f32 v178, v180, v181
    v_cvt_pk_bf16_f32 v179, v182, v183
    v_cvt_pk_bf16_f32 v180, v184, v185
    v_cvt_pk_bf16_f32 v181, v186, v187
    v_cvt_pk_bf16_f32 v182, v188, v189
    v_cvt_pk_bf16_f32 v183, v190, v191
    v_cndmask_b32 v182, 0, v182, vcc
    v_cndmask_b32 v183, 0, v183, vcc
    s_lshl_b32 s65, s73, 4
    s_add_u32 s65, s65, s71
    s_lshl_b32 s65, s65, 11
    s_add_u32 s65, s65, 0x800000
    buffer_store_dwordx4 v[176:179], v1, s[32:35], s65 offen sc1
    buffer_store_dwordx4 v[180:183], v1, s[32:35], s65 offen offset:1024 sc1
L2_stored:
    s_waitcnt vmcnt(0)
    s_barrier
    s_cmp_eq_u32 s54, 0
    s_cbranch_scc0 L2_done
    s_lshl_b32 s65, s72, 5
    s_add_u32 s65, s65, s71
    s_lshl_b32 s65, s65, 7
    s_add_u32 s65, s65, 0xd18000
    v_mov_b32 v10, 0
    v_mov_b32 v11, s58
    s_mov_b64 exec, 1
    buffer_store_dword v11, v10, s[32:35], s65 offen sc1
    s_mov_b64 exec, -1
L2_done:
    s_cmp_ge_u32 s53, 28
    s_cbranch_scc1 L_fin
    s_lshl_b32 s65, s52, 2
    s_and_b32 s66, s53, 3
    s_add_u32 s71, s65, s66
    s_and_b32 s72, s54, 1
    s_lshr_b32 s73, s54, 1
    s_lshl_b32 s75, s71, 1
    s_add_u32 s75, s75, s73
    s_lshr_b32 s65, s71, 1
    s_lshl_b32 s65, s65, 12
    s_add_u32 s65, s65, 0xd18000
    s_lshr_b32 s66, s75, 1
    s_lshl_b32 s66, s66, 11
    s_add_u32 s66, s66, 0xd50000
    s_cmp_eq_u32 s72, 1
    s_cselect_b32 s65, s65, s66
    s_lshl_b32 s66, s75, 8
    s_add_u32 s66, s66, 0xd27400
    v_lshlrev_b32 v3, 7, v0
    v_add_u32 v4, s65, v3
    v_add_u32 v5, s66, v3
    v_cmp_gt_u32 vcc, 24, v0
    s_cmp_eq_u32 s72, 1
    s_mov_b32 s67, 0x0300ffff
    v_cndmask_b32 v3, v5, v4, vcc
    v_min_u32 v3, 0xfffffc, v3
    s_mov_b32 s74, 0
L_poll_12:
    buffer_load_dword v4, v3, s[32:35], 0 offen sc1
    s_waitcnt vmcnt(0)
    v_cmp_eq_u32 vcc, s58, v4
    s_add_u32 s74, s74, 1
    s_cmp_gt_u32 s74, 400000
    s_cbranch_scc1 L_polled_13
    s_and_b32 s70, vcc_lo, s67
    s_cmp_eq_u32 s70, s67
    s_cbranch_scc1 L_polled_13
    s_sleep 2
    s_branch L_poll_12
L_polled_13:
    v_and_b32 v4, 31, v0
    v_lshlrev_b32 v5, 2, v4
    s_lshl_b32 s65, s75, 7
    s_add_u32 s66, s65, 0xd00000
    buffer_load_dword v6, v5, s[32:35], s66 offen sc1
    s_lshl_b32 s65, s75, 15
    s_cmp_eq_u32 s72, 1
    s_mov_b32 s66, 0xa00000
    s_cselect_b32 s66, 0x800000, s66
    s_add_u32 s65, s65, s66
    s_mov_b32 s13, s65
    buffer_load_dwordx4 v[32:35], v1, s[32:35], s13 offen offset:0 sc1
    buffer_load_dwordx4 v[36:39], v1, s[32:35], s13 offen offset:1024 sc1
    buffer_load_dwordx4 v[40:43], v1, s[32:35], s13 offen offset:2048 sc1
    buffer_load_dwordx4 v[44:47], v1, s[32:35], s13 offen offset:3072 sc1
    s_add_u32 s13, s13, 4096
    buffer_load_dwordx4 v[48:51], v1, s[32:35], s13 offen offset:0 sc1
    buffer_load_dwordx4 v[52:55], v1, s[32:35], s13 offen offset:1024 sc1
    buffer_load_dwordx4 v[56:59], v1, s[32:35], s13 offen offset:2048 sc1
    buffer_load_dwordx4 v[60:63], v1, s[32:35], s13 offen offset:3072 sc1
    s_add_u32 s13, s13, 4096
    buffer_load_dwordx4 v[64:67], v1, s[32:35], s13 offen offset:0 sc1
    buffer_load_dwordx4 v[68:71], v1, s[32:35], s13 offen offset:1024 sc1
    buffer_load_dwordx4 v[72:75], v1, s[32:35], s13 offen offset:2048 sc1
    buffer_load_dwordx4 v[76:79], v1, s[32:35], s13 offen offset:3072 sc1
    s_add_u32 s13, s13, 4096
    buffer_load_dwordx4 v[80:83], v1, s[32:35], s13 offen offset:0 sc1
    buffer_load_dwordx4 v[84:87], v1, s[32:35], s13 offen offset:1024 sc1
    buffer_load_dwordx4 v[88:91], v1, s[32:35], s13 offen offset:2048 sc1
    buffer_load_dwordx4 v[92:95], v1, s[32:35], s13 offen offset:3072 sc1
    s_add_u32 s13, s13, 4096
    v_lshrrev_b32 v7, 5, v0
    v_bfe_u32 v8, v0, 2, 2
    v_lshl_add_u32 v8, v7, 2, v8
    v_lshlrev_b32 v8, 7, v8
    v_bfe_u32 v9, v0, 4, 1
    v_lshlrev_b32 v9, 5, v9
    v_and_b32 v10, 3, v0
    v_lshl_add_u32 v9, v10, 3, v9
    v_bfe_u32 v10, v0, 3, 1
    v_lshlrev_b32 v10, 6, v10
    v_xor_b32 v9, v9, v10
    v_add_u32 v8, v8, v9
    s_mul_i32 s65, s72, 57344
    v_add_u32 v8, s65, v8
    v_xor_b32 v9, 64, v8
    s_lshl_b32 s65, s54, 12
    s_add_u32 s65, s65, 115712
    v_add_u32 v10, s65, v1
    s_xor_b32 s65, s54, 1
    s_lshl_b32 s65, s65, 12
    s_add_u32 s65, s65, 115712
    v_add_u32 v11, s65, v1
    ds_read_b64_tr_b16 v[12:13], v8 offset:0
    ds_read_b64_tr_b16 v[14:15], v8 offset:1024
    ds_read_b64_tr_b16 v[16:17], v9 offset:0
    ds_read_b64_tr_b16 v[18:19], v9 offset:1024
    s_waitcnt vmcnt(14) lgkmcnt(0)
    v_mfma_f32_32x32x16_bf16 v[160:175], v[12:15], v[32:35], 0
    ds_read_b64_tr_b16 v[20:21], v8 offset:2048
    ds_read_b64_tr_b16 v[22:23], v8 offset:3072
    ds_read_b64_tr_b16 v[24:25], v9 offset:2048
    ds_read_b64_tr_b16 v[26:27], v9 offset:3072
    v_mfma_f32_32x32x16_bf16 v[176:191], v[16:19], v[32:35], 0
    buffer_load_dwordx4 v[96:99], v1, s[32:35], s13 offen offset:0 sc1
    s_waitcnt lgkmcnt(0)
    v_mfma_f32_32x32x16_bf16 v[160:175], v[20:23], v[36:39], v[160:175]
    ds_read_b64_tr_b16 v[12:13], v8 offset:3584
    ds_read_b64_tr_b16 v[14:15], v8 offset:4608
    ds_read_b64_tr_b16 v[16:17], v9 offset:3584
    ds_read_b64_tr_b16 v[18:19], v9 offset:4608
    v_mfma_f32_32x32x16_bf16 v[176:191], v[24:27], v[36:39], v[176:191]
    buffer_load_dwordx4 v[100:103], v1, s[32:35], s13 offen offset:1024 sc1
    s_waitcnt vmcnt(14) lgkmcnt(0)
    v_mfma_f32_32x32x16_bf16 v[160:175], v[12:15], v[40:43], v[160:175]
    ds_read_b64_tr_b16 v[20:21], v8 offset:5632
    ds_read_b64_tr_b16 v[22:23], v8 offset:6656
    ds_read_b64_tr_b16 v[24:25], v9 offset:5632
    ds_read_b64_tr_b16 v[26:27], v9 offset:6656
    v_mfma_f32_32x32x16_bf16 v[176:191], v[16:19], v[40:43], v[176:191]
    buffer_load_dwordx4 v[104:107], v1, s[32:35], s13 offen offset:2048 sc1
    s_waitcnt lgkmcnt(0)
    v_mfma_f32_32x32x16_bf16 v[160:175], v[20:23], v[44:47], v[160:175]
    ds_read_b64_tr_b16 v[12:13], v8 offset:7168
    ds_read_b64_tr_b16 v[14:15], v8 offset:8192
    ds_read_b64_tr_b16 v[16:17], v9 offset:7168
    ds_read_b64_tr_b16 v[18:19], v9 offset:8192
    v_mfma_f32_32x32x16_bf16 v[176:191], v[24:27], v[44:47], v[176:191]
    buffer_load_dwordx4 v[108:111], v1, s[32:35], s13 offen offset:3072 sc1
    s_add_u32 s13, s13, 4096
    s_waitcnt vmcnt(14) lgkmcnt(0)
    v_mfma_f32_32x32x16_bf16 v[160:175], v[12:15], v[48:51], v[160:175]
    ds_read_b64_tr_b16 v[20:21], v8 offset:9216
    ds_read_b64_tr_b16 v[22:23], v8 offset:10240
    ds_read_b64_tr_b16 v[24:25], v9 offset:9216
    ds_read_b64_tr_b16 v[26:27], v9 offset:10240
    v_mfma_f32_32x32x16_bf16 v[176:191], v[16:19], v[48:51], v[176:191]
    buffer_load_dwordx4 v[112:115], v1, s[32:35], s13 offen offset:0 sc1
    s_waitcnt lgkmcnt(0)
    v_mfma_f32_32x32x16_bf16 v[160:175], v[20:23], v[52:55], v[160:175]
    ds_read_b64_tr_b16 v[12:13], v8 offset:10752
    ds_read_b64_tr_b16 v[14:15], v8 offset:11776
    ds_read_b64_tr_b16 v[16:17], v9 offset:10752
    ds_read_b64_tr_b16 v[18:19], v9 offset:11776
    v_mfma_f32_32x32x16_bf16 v[176:191], v[24:27], v[52:55], v[176:191]
    buffer_load_dwordx4 v[116:119], v1, s[32:35], s13 offen offset:1024 sc1
    s_waitcnt vmcnt(14) lgkmcnt(0)
    v_mfma_f32_32x32x16_bf16 v[160:175], v[12:15], v[56:59], v[160:175]
    ds_read_b64_tr_b16 v[20:21], v8 offset:12800
    ds_read_b64_tr_b16 v[22:23], v8 offset:13824
    ds_read_b64_tr_b16 v[24:25], v9 offset:12800
    ds_read_b64_tr_b16 v[26:27], v9 offset:13824
    v_mfma_f32_32x32x16_bf16 v[176:191], v[16:19], v[56:59], v[176:191]
    buffer_load_dwordx4 v[120:123], v1, s[32:35], s13 offen offset:2048 sc1
    s_waitcnt lgkmcnt(0)
    v_mfma_f32_32x32x16_bf16 v[160:175], v[20:23], v[60:63], v[160:175]
    ds_read_b64_tr_b16 v[12:13], v8 offset:14336
    ds_read_b64_tr_b16 v[14:15], v8 offset:15360
    ds_read_b64_tr_b16 v[16:17], v9 offset:14336
    ds_read_b64_tr_b16 v[18:19], v9 offset:15360
    v_mfma_f32_32x32x16_bf16 v[176:191], v[24:27], v[60:63], v[176:191]
    buffer_load_dwordx4 v[124:127], v1, s[32:35], s13 offen offset:3072 sc1
    s_add_u32 s13, s13, 4096
    s_waitcnt vmcnt(14) lgkmcnt(0)
    v_mfma_f32_32x32x16_bf16 v[160:175], v[12:15], v[64:67], v[160:175]
    ds_read_b64_tr_b16 v[20:21], v8 offset:16384
    ds_read_b64_tr_b16 v[22:23], v8 offset:17408
    ds_read_b64_tr_b16 v[24:25], v9 offset:16384
    ds_read_b64_tr_b16 v[26:27], v9 offset:17408
    v_mfma_f32_32x32x16_bf16 v[176:191], v[16:19], v[64:67], v[176:191]
    buffer_load_dwordx4 v[128:131], v1, s[32:35], s13 offen offset:0 sc1
    s_waitcnt lgkmcnt(0)
    v_mfma_f32_32x32x16_bf16 v[160:175], v[20:23], v[68:71], v[160:175]
    ds_read_b64_tr_b16 v[12:13], v8 offset:17920
    ds_read_b64_tr_b16 v[14:15], v8 offset:18944
    ds_read_b64_tr_b16 v[16:17], v9 offset:17920
    ds_read_b64_tr_b16 v[18:19], v9 offset:18944
    v_mfma_f32_32x32x16_bf16 v[176:191], v[24:27], v[68:71], v[176:191]
    buffer_load_dwordx4 v[132:135], v1, s[32:35], s13 offen offset:1024 sc1
    s_waitcnt vmcnt(14) lgkmcnt(0)
    v_mfma_f32_32x32x16_bf16 v[160:175], v[12:15], v[72:75], v[160:175]
    ds_read_b64_tr_b16 v[20:21], v8 offset:19968
    ds_read_b64_tr_b16 v[22:23], v8 offset:20992
    ds_read_b64_tr_b16 v[24:25], v9 offset:19968
    ds_read_b64_tr_b16 v[26:27], v9 offset:20992
    v_mfma_f32_32x32x16_bf16 v[176:191], v[16:19], v[72:75], v[176:191]
    buffer_load_dwordx4 v[136:139], v1, s[32:35], s13 offen offset:2048 sc1
    s_waitcnt lgkmcnt(0)
    v_mfma_f32_32x32x16_bf16 v[160:175], v[20:23], v[76:79], v[160:175]
    ds_read_b64_tr_b16 v[12:13], v8 offset:21504
    ds_read_b64_tr_b16 v[14:15], v8 offset:22528
    ds_read_b64_tr_b16 v[16:17], v9 offset:21504
    ds_read_b64_tr_b16 v[18:19], v9 offset:22528
    v_mfma_f32_32x32x16_bf16 v[176:191], v[24:27], v[76:79], v[176:191]
    buffer_load_dwordx4 v[140:143], v1, s[32:35], s13 offen offset:3072 sc1
    s_add_u32 s13, s13, 4096
    s_waitcnt vmcnt(14) lgkmcnt(0)
    v_mfma_f32_32x32x16_bf16 v[160:175], v[12:15], v[80:83], v[160:175]
    ds_read_b64_tr_b16 v[20:21], v8 offset:23552
    ds_read_b64_tr_b16 v[22:23], v8 offset:24576
    ds_read_b64_tr_b16 v[24:25], v9 offset:23552
    ds_read_b64_tr_b16 v[26:27], v9 offset:24576
    v_mfma_f32_32x32x16_bf16 v[176:191], v[16:19], v[80:83], v[176:191]
    buffer_load_dwordx4 v[144:147], v1, s[32:35], s13 offen offset:0 sc1
    s_waitcnt lgkmcnt(0)
    v_mfma_f32_32x32x16_bf16 v[160:175], v[20:23], v[84:87], v[160:175]
    ds_read_b64_tr_b16 v[12:13], v8 offset:25088
    ds_read_b64_tr_b16 v[14:15], v8 offset:26112
    ds_read_b64_tr_b16 v[16:17], v9 offset:25088
    ds_read_b64_tr_b16 v[18:19], v9 offset:26112
    v_mfma_f32_32x32x16_bf16 v[176:191], v[24:27], v[84:87], v[176:191]
    buffer_load_dwordx4 v[148:151], v1, s[32:35], s13 offen offset:1024 sc1
    s_waitcnt vmcnt(14) lgkmcnt(0)
    v_mfma_f32_32x32x16_bf16 v[160:175], v[12:15], v[88:91], v[160:175]
    ds_read_b64_tr_b16 v[20:21], v8 offset:27136
    ds_read_b64_tr_b16 v[22:23], v8 offset:28160
    ds_read_b64_tr_b16 v[24:25], v9 offset:27136
    ds_read_b64_tr_b16 v[26:27], v9 offset:28160
    v_mfma_f32_32x32x16_bf16 v[176:191], v[16:19], v[88:91], v[176:191]
    buffer_load_dwordx4 v[152:155], v1, s[32:35], s13 offen offset:2048 sc1
    s_waitcnt lgkmcnt(0)
    v_mfma_f32_32x32x16_bf16 v[160:175], v[20:23], v[92:95], v[160:175]
    ds_read_b64_tr_b16 v[12:13], v8 offset:28672
    ds_read_b64_tr_b16 v[14:15], v8 offset:29696
    ds_read_b64_tr_b16 v[16:17], v9 offset:28672
    ds_read_b64_tr_b16 v[18:19], v9 offset:29696
    v_mfma_f32_32x32x16_bf16 v[176:191], v[24:27], v[92:95], v[176:191]
    buffer_load_dwordx4 v[156:159], v1, s[32:35], s13 offen offset:3072 sc1
    s_add_u32 s13, s13, 4096
    s_waitcnt vmcnt(14) lgkmcnt(0)
    v_mfma_f32_32x32x16_bf16 v[160:175], v[12:15], v[96:99], v[160:175]
    ds_read_b64_tr_b16 v[20:21], v8 offset:30720
    ds_read_b64_tr_b16 v[22:23], v8 offset:31744
    ds_read_b64_tr_b16 v[24:25], v9 offset:30720
    ds_read_b64_tr_b16 v[26:27], v9 offset:31744
    v_mfma_f32_32x32x16_bf16 v[176:191], v[16:19], v[96:99], v[176:191]
    s_waitcnt lgkmcnt(0)
    v_mfma_f32_32x32x16_bf16 v[160:175], v[20:23], v[100:103], v[160:175]
    ds_read_b64_tr_b16 v[12:13], v8 offset:32256
    ds_read_b64_tr_b16 v[14:15], v8 offset:33280
    ds_read_b64_tr_b16 v[16:17], v9 offset:32256
    ds_read_b64_tr_b16 v[18:19], v9 offset:33280
    v_mfma_f32_32x32x16_bf16 v[176:191], v[24:27], v[100:103], v[176:191]
    s_waitcnt vmcnt(12) lgkmcnt(0)
    v_mfma_f32_32x32x16_bf16 v[160:175], v[12:15], v[104:107], v[160:175]
    ds_read_b64_tr_b16 v[20:21], v8 offset:34304
    ds_read_b64_tr_b16 v[22:23], v8 offset:35328
    ds_read_b64_tr_b16 v[24:25], v9 offset:34304
    ds_read_b64_tr_b16 v[26:27], v9 offset:35328
    v_mfma_f32_32x32x16_bf16 v[176:191], v[16:19], v[104:107], v[176:191]
    s_waitcnt lgkmcnt(0)
    v_mfma_f32_32x32x16_bf16 v[160:175], v[20:23], v[108:111], v[160:175]
    ds_read_b64_tr_b16 v[12:13], v8 offset:35840
    ds_read_b64_tr_b16 v[14:15], v8 offset:36864
    ds_read_b64_tr_b16 v[16:17], v9 offset:35840
    ds_read_b64_tr_b16 v[18:19], v9 offset:36864
    v_mfma_f32_32x32x16_bf16 v[176:191], v[24:27], v[108:111], v[176:191]
    s_waitcnt vmcnt(10) lgkmcnt(0)
    v_mfma_f32_32x32x16_bf16 v[160:175], v[12:15], v[112:115], v[160:175]
    ds_read_b64_tr_b16 v[20:21], v8 offset:37888
    ds_read_b64_tr_b16 v[22:23], v8 offset:38912
    ds_read_b64_tr_b16 v[24:25], v9 offset:37888
    ds_read_b64_tr_b16 v[26:27], v9 offset:38912
    v_mfma_f32_32x32x16_bf16 v[176:191], v[16:19], v[112:115], v[176:191]
    s_waitcnt lgkmcnt(0)
    v_mfma_f32_32x32x16_bf16 v[160:175], v[20:23], v[116:119], v[160:175]
    ds_read_b64_tr_b16 v[12:13], v8 offset:39424
    ds_read_b64_tr_b16 v[14:15], v8 offset:40448
    ds_read_b64_tr_b16 v[16:17], v9 offset:39424
    ds_read_b64_tr_b16 v[18:19], v9 offset:40448
    v_mfma_f32_32x32x16_bf16 v[176:191], v[24:27], v[116:119], v[176:191]
    s_waitcnt vmcnt(8) lgkmcnt(0)
    v_mfma_f32_32x32x16_bf16 v[160:175], v[12:15], v[120:123], v[160:175]
    ds_read_b64_tr_b16 v[20:21], v8 offset:41472
    ds_read_b64_tr_b16 v[22:23], v8 offset:42496
    ds_read_b64_tr_b16 v[24:25], v9 offset:41472
    ds_read_b64_tr_b16 v[26:27], v9 offset:42496
    v_mfma_f32_32x32x16_bf16 v[176:191], v[16:19], v[120:123], v[176:191]
    s_waitcnt lgkmcnt(0)
    v_mfma_f32_32x32x16_bf16 v[160:175], v[20:23], v[124:127], v[160:175]
    ds_read_b64_tr_b16 v[12:13], v8 offset:43008
    ds_read_b64_tr_b16 v[14:15], v8 offset:44032
    ds_read_b64_tr_b16 v[16:17], v9 offset:43008
    ds_read_b64_tr_b16 v[18:19], v9 offset:44032
    v_mfma_f32_32x32x16_bf16 v[176:191], v[24:27], v[124:127], v[176:191]
    s_waitcnt vmcnt(6) lgkmcnt(0)
    v_mfma_f32_32x32x16_bf16 v[160:175], v[12:15], v[128:131], v[160:175]
    ds_read_b64_tr_b16 v[20:21], v8 offset:45056
    ds_read_b64_tr_b16 v[22:23], v8 offset:46080
    ds_read_b64_tr_b16 v[24:25], v9 offset:45056
    ds_read_b64_tr_b16 v[26:27], v9 offset:46080
    v_mfma_f32_32x32x16_bf16 v[176:191], v[16:19], v[128:131], v[176:191]
    s_waitcnt lgkmcnt(0)
    v_mfma_f32_32x32x16_bf16 v[160:175], v[20:23], v[132:135], v[160:175]
    ds_read_b64_tr_b16 v[12:13], v8 offset:46592
    ds_read_b64_tr_b16 v[14:15], v8 offset:47616
    ds_read_b64_tr_b16 v[16:17], v9 offset:46592
    ds_read_b64_tr_b16 v[18:19], v9 offset:47616
    v_mfma_f32_32x32x16_bf16 v[176:191], v[24:27], v[132:135], v[176:191]
    s_waitcnt vmcnt(4) lgkmcnt(0)
    v_mfma_f32_32x32x16_bf16 v[160:175], v[12:15], v[136:139], v[160:175]
    ds_read_b64_tr_b16 v[20:21], v8 offset:48640
    ds_read_b64_tr_b16 v[22:23], v8 offset:49664
    ds_read_b64_tr_b16 v[24:25], v9 offset:48640
    ds_read_b64_tr_b16 v[26:27], v9 offset:49664
    v_mfma_f32_32x32x16_bf16 v[176:191], v[16:19], v[136:139], v[176:191]
    s_waitcnt lgkmcnt(0)
    v_mfma_f32_32x32x16_bf16 v[160:175], v[20:23], v[140:143], v[160:175]
    ds_read_b64_tr_b16 v[12:13], v8 offset:50176
    ds_read_b64_tr_b16 v[14:15], v8 offset:51200
    ds_read_b64_tr_b16 v[16:17], v9 offset:50176
    ds_read_b64_tr_b16 v[18:19], v9 offset:51200
    v_mfma_f32_32x32x16_bf16 v[176:191], v[24:27], v[140:143], v[176:191]
    s_waitcnt vmcnt(2) lgkmcnt(0)
    v_mfma_f32_32x32x16_bf16 v[160:175], v[12:15], v[144:147], v[160:175]
    ds_read_b64_tr_b16 v[20:21], v8 offset:52224
    ds_read_b64_tr_b16 v[22:23], v8 offset:53248
    ds_read_b64_tr_b16 v[24:25], v9 offset:52224
    ds_read_b64_tr_b16 v[26:27], v9 offset:53248
    v_mfma_f32_32x32x16_bf16 v[176:191], v[16:19], v[144:147], v[176:191]
    s_waitcnt lgkmcnt(0)
    v_mfma_f32_32x32x16_bf16 v[160:175], v[20:23], v[148:151], v[160:175]
    ds_read_b64_tr_b16 v[12:13], v8 offset:53760
    ds_read_b64_tr_b16 v[14:15], v8 offset:54784
    ds_read_b64_tr_b16 v[16:17], v9 offset:53760
    ds_read_b64_tr_b16 v[18:19], v9 offset:54784
    v_mfma_f32_32x32x16_bf16 v[176:191], v[24:27], v[148:151], v[176:191]
    s_waitcnt vmcnt(0) lgkmcnt(0)
    v_mfma_f32_32x32x16_bf16 v[160:175], v[12:15], v[152:155], v[160:175]
    ds_read_b64_tr_b16 v[20:21], v8 offset:55808
    ds_read_b64_tr_b16 v[22:23], v8 offset:56832
    ds_read_b64_tr_b16 v[24:25], v9 offset:55808
    ds_read_b64_tr_b16 v[26:27], v9 offset:56832
    v_mfma_f32_32x32x16_bf16 v[176:191], v[16:19], v[152:155], v[176:191]
    s_waitcnt lgkmcnt(0)
    v_mfma_f32_32x32x16_bf16 v[160:175], v[20:23], v[156:159], v[160:175]
    v_mfma_f32_32x32x16_bf16 v[176:191], v[24:27], v[156:159], v[176:191]
    v_mul_u32_u24 v4, 896, v4
    v_lshl_add_u32 v4, v7, 4, v4
    s_mul_i32 s65, s75, 28672
    s_lshl_b32 s66, s72, 6
    s_add_u32 s65, s65, s66
    s_lshr_b32 s66, s53, 2
    s_lshl_b32 s66, s66, 7
    s_add_u32 s65, s65, s66
    s_cmp_eq_u32 s72, 1
    s_cbranch_scc1 L3_b1
    v_mov_b32 v12, v6
    v_mov_b32 v13, v6
    v_pk_mul_f32 v[176:177], v[176:177], v[12:13]
    v_pk_mul_f32 v[178:179], v[178:179], v[12:13]
    v_pk_mul_f32 v[180:181], v[180:181], v[12:13]
    v_pk_mul_f32 v[182:183], v[182:183], v[12:13]
    v_pk_mul_f32 v[184:185], v[184:185], v[12:13]
    v_pk_mul_f32 v[186:187], v[186:187], v[12:13]
    v_pk_mul_f32 v[188:189], v[188:189], v[12:13]
    v_pk_mul_f32 v[190:191], v[190:191], v[12:13]
    ds_write_b128 v10, v[176:179] offset:0
    ds_write_b128 v10, v[180:183] offset:1024
    ds_write_b128 v10, v[184:187] offset:2048
    ds_write_b128 v10, v[188:191] offset:3072
    v_pk_mul_f32 v[160:161], v[160:161], v[12:13]
    v_pk_mul_f32 v[162:163], v[162:163], v[12:13]
    v_pk_mul_f32 v[164:165], v[164:165], v[12:13]
    v_pk_mul_f32 v[166:167], v[166:167], v[12:13]
    v_pk_mul_f32 v[168:169], v[168:169], v[12:13]
    v_pk_mul_f32 v[170:171], v[170:171], v[12:13]
    v_pk_mul_f32 v[172:173], v[172:173], v[12:13]
    v_pk_mul_f32 v[174:175], v[174:175], v[12:13]
    s_branch L3_x
L3_b1:
    v_sub_f32 v12, 1.0, v6
    v_sub_f32 v13, 1.0, v6
    v_pk_mul_f32 v[160:161], v[160:161], v[12:13]
    v_pk_mul_f32 v[162:163], v[162:163], v[12:13]
    v_pk_mul_f32 v[164:165], v[164:165], v[12:13]
    v_pk_mul_f32 v[166:167], v[166:167], v[12:13]
    v_pk_mul_f32 v[168:169], v[168:169], v[12:13]
    v_pk_mul_f32 v[170:171], v[170:171], v[12:13]
    v_pk_mul_f32 v[172:173], v[172:173], v[12:13]
    v_pk_mul_f32 v[174:175], v[174:175], v[12:13]
    ds_write_b128 v10, v[160:163] offset:0
    ds_write_b128 v10, v[164:167] offset:1024
    ds_write_b128 v10, v[168:171] offset:2048
    ds_write_b128 v10, v[172:175] offset:3072
    s_nop 1
    v_pk_mul_f32 v[160:161], v[176:177], v[12:13]
    v_pk_mul_f32 v[162:163], v[178:179], v[12:13]
    v_pk_mul_f32 v[164:165], v[180:181], v[12:13]
    v_pk_mul_f32 v[166:167], v[182:183], v[12:13]
    v_pk_mul_f32 v[168:169], v[184:185], v[12:13]
    v_pk_mul_f32 v[170:171], v[186:187], v[12:13]
    v_pk_mul_f32 v[172:173], v[188:189], v[12:13]
    v_pk_mul_f32 v[174:175], v[190:191], v[12:13]
L3_x:
    s_waitcnt lgkmcnt(0)
    s_barrier
    ds_read_b128 v[176:179], v11 offset:0
    ds_read_b128 v[180:183], v11 offset:1024
    ds_read_b128 v[184:187], v11 offset:2048
    ds_read_b128 v[188:191], v11 offset:3072
    s_waitcnt lgkmcnt(0)
    v_pk_add_f32 v[160:161], v[176:177], v[160:161]
    v_pk_add_f32 v[162:163], v[178:179], v[162:163]
    v_pk_add_f32 v[164:165], v[180:181], v[164:165]
    v_pk_add_f32 v[166:167], v[182:183], v[166:167]
    v_pk_add_f32 v[168:169], v[184:185], v[168:169]
    v_pk_add_f32 v[170:171], v[186:187], v[170:171]
    v_pk_add_f32 v[172:173], v[188:189], v[172:173]
    v_pk_add_f32 v[174:175], v[190:191], v[174:175]
    v_cvt_pk_bf16_f32 v160, v160, v161
    v_cvt_pk_bf16_f32 v161, v162, v163
    v_cvt_pk_bf16_f32 v162, v164, v165
    v_cvt_pk_bf16_f32 v163, v166, v167
    v_cvt_pk_bf16_f32 v164, v168, v169
    v_cvt_pk_bf16_f32 v165, v170, v171
    v_cvt_pk_bf16_f32 v166, v172, v173
    v_cvt_pk_bf16_f32 v167, v174, v175
    s_nop 1
    v_permlane32_swap_b32 v160, v162
    v_permlane32_swap_b32 v161, v163
    v_permlane32_swap_b32 v164, v166
    v_permlane32_swap_b32 v165, v167
    buffer_store_dwordx4 v[160:163], v4, s[40:43], s65 offen offset:0
    buffer_store_dwordx4 v[164:167], v4, s[40:43], s65 offen offset:32
L_fin:
L_end:
    s_endpgm
L_loader:
    s_sub_u32 s54, s54, 4
    v_lshrrev_b32 v11, 3, v0
    v_and_b32 v12, 7, v0
    v_lshrrev_b32 v13, 4, v0
    v_xor_b32 v14, v12, v13
    v_mul_u32_u24 v15, 896, v11
    v_lshl_add_u32 v2, v14, 4, v15
    v_xor_b32 v3, 64, v2
    s_lshl_b32 s65, s56, 7
    s_lshl_b32 s66, s54, 5
    s_add_u32 s65, s65, s66
    s_mul_i32 s59, s65, 896
    s_mul_i32 s60, s54, 43008
    v_mov_b32 v5, 0
    s_cmp_eq_u32 s55, 1
    s_cbranch_scc1 LL_setB
    v_and_b32 v13, 1, v13
    v_lshlrev_b32 v13, 2, v13
    v_xor_b32 v14, v12, v13
    v_mul_u32_u24 v15, 2688, v11
    v_lshl_add_u32 v4, v14, 4, v15
    s_mul_i32 s66, s57, 112
    s_add_u32 s60, s60, s66
    s_branch LL_setdone
LL_setB:
    s_mul_i32 s65, s57, 336
    s_and_b32 s66, s65, 127
    s_sub_u32 s65, s65, s66
    s_add_u32 s60, s60, s65
    s_add_u32 s65, s66, 463
    s_lshr_b32 s65, s65, 7
    s_lshl_b32 s65, s65, 3
    v_lshrrev_b32 v11, 5, v0
    v_and_b32 v12, 31, v0
    v_lshlrev_b32 v13, 2, v11
    v_xor_b32 v12, v12, v13
    v_mul_u32_u24 v15, 2688, v11
    v_lshl_add_u32 v4, v12, 4, v15
    v_cmp_gt_u32 vcc, s65, v12
    v_xor_b32 v12, 8, v12
    v_mov_b32 v13, 0x7ffffff0
    v_cndmask_b32 v4, v13, v4, vcc
    v_lshl_add_u32 v5, v12, 4, v15
    v_cmp_gt_u32 vcc, s65, v12
    s_nop 1
    v_cndmask_b32 v5, v13, v5, vcc
LL_setdone:
    s_cmp_eq_u32 s54, 0
    s_cbranch_scc0 LL_tw
    v_mul_u32_u24 v6, 896, v0
    v_cmp_gt_u32 vcc, 32, v0
    s_lshr_b32 s65, s53, 3
    s_lshl_b32 s65, s65, 5
    s_lshl_b32 s66, s56, 7
    s_add_u32 s65, s65, s66
    s_mul_i32 s84, s65, 896
    s_mov_b32 s85, 128
    s_branch LL_td
LL_tw:
    v_and_b32 v11, 7, v0
    v_mul_u32_u24 v6, 2688, v11
    v_bfe_u32 v11, v0, 3, 1
    v_lshl_add_u32 v6, v11, 7, v6
    v_cmp_gt_u32 vcc, 16, v0
    s_and_b32 s65, s53, 7
    s_mul_i32 s84, s65, 21504
    s_sub_u32 s65, s54, 1
    s_mul_i32 s66, s65, 896
    s_mul_i32 s67, s57, 112
    s_cmp_eq_u32 s55, 1
    s_cbranch_scc0 LL_ta
    s_lshl_b32 s66, s65, 8
    s_mul_i32 s67, s57, 336
LL_ta:
    s_and_b32 s67, s67, 0xffffff80
    s_add_u32 s66, s66, s67
    s_add_u32 s84, s84, s66
    s_mov_b32 s85, 172032
LL_td:
    v_mov_b32 v11, 0x7ffffff0
    s_mul_i32 s65, s85, 2
    v_cndmask_b32 v6, v11, v6, vcc
    s_add_u32 s84, s84, s65
    s_mov_b32 s82, 2
    s_waitcnt lgkmcnt(0)
    s_mov_b32 s24, s4
    s_mov_b32 s25, s5
    s_mov_b32 s26, 0x1c0000
    s_mov_b32 s27, 0x20000
    s_cmp_eq_u32 s55, 1
    s_cselect_b32 s28, s12, s6
    s_cselect_b32 s29, s13, s7
    s_mov_b32 s30, 0x126000
    s_mov_b32 s31, 0x20000
    s_mov_b32 s62, 0
    s_mov_b32 s61, 0
    s_cbranch_scc1 LL_B
LL_A:
LL_proA:
    s_lshl_b32 s65, s54, 12
    s_add_u32 s65, s65, s62
    s_mov_b32 m0, s65
    s_mov_b32 s63, s59
    buffer_load_dwordx4 v2, s[24:27], s63 offen offset:0 lds
    s_add_u32 s63, s59, 6144
    buffer_load_dwordx4 v3, s[24:27], s63 offen offset:1024 lds
    s_add_u32 s63, s59, 12288
    buffer_load_dwordx4 v2, s[24:27], s63 offen offset:2048 lds
    s_add_u32 s63, s59, 18432
    buffer_load_dwordx4 v3, s[24:27], s63 offen offset:3072 lds
    s_lshl_b32 s66, s54, 11
    s_add_u32 s66, s66, s62
    s_add_u32 s65, s66, 16384
    s_mov_b32 m0, s65
    s_add_u32 s63, s60, 0
    buffer_load_dwordx4 v4, s[28:31], s63 offen offset:0 lds
    s_add_u32 s63, s60, 20480
    buffer_load_dwordx4 v4, s[28:31], s63 offen offset:1024 lds
    s_add_u32 s65, s66, 24576
    s_mov_b32 m0, s65
    s_add_u32 s63, s60, 896
    buffer_load_dwordx4 v4, s[28:31], s63 offen offset:0 lds
    s_add_u32 s63, s60, 21376
    buffer_load_dwordx4 v4, s[28:31], s63 offen offset:1024 lds
    s_add_u32 s65, s66, 32768
    s_mov_b32 m0, s65
    s_add_u32 s63, s60, 1792
    buffer_load_dwordx4 v4, s[28:31], s63 offen offset:0 lds
    s_add_u32 s63, s60, 22272
    buffer_load_dwordx4 v4, s[28:31], s63 offen offset:1024 lds
    s_add_u32 s59, s59, 128
    s_add_u32 s60, s60, 172032
    s_add_u32 s62, s62, 40960
    s_cmp_eq_u32 s62, 122880
    s_cselect_b32 s62, 0, s62
    s_add_u32 s61, s61, 1
    s_cmp_lt_u32 s61, 2
    s_cbranch_scc1 LL_proA
    s_cmp_eq_u32 s54, 0
    s_cselect_b32 s76, s24, s28
    s_cselect_b32 s77, s25, s29
    s_cselect_b32 s78, s26, s30
    s_mov_b32 s79, 0x20000
    buffer_load_dword v140, v6, s[76:79], s84 offen
    s_cmp_lt_u32 s82, 6
    s_cselect_b32 s65, s85, 0
    s_add_u32 s84, s84, s65
    s_add_u32 s82, s82, 1
    s_waitcnt vmcnt(11)
    s_barrier
    s_lshl_b32 s65, s54, 12
    s_add_u32 s65, s65, s62
    s_mov_b32 m0, s65
    s_mov_b32 s63, s59
    buffer_load_dwordx4 v2, s[24:27], s63 offen offset:0 lds
    s_add_u32 s63, s59, 6144
    buffer_load_dwordx4 v3, s[24:27], s63 offen offset:1024 lds
    s_add_u32 s63, s59, 12288
    buffer_load_dwordx4 v2, s[24:27], s63 offen offset:2048 lds
    s_add_u32 s63, s59, 18432
    buffer_load_dwordx4 v3, s[24:27], s63 offen offset:3072 lds
    s_lshl_b32 s66, s54, 11
    s_add_u32 s66, s66, s62
    s_add_u32 s65, s66, 16384
    s_mov_b32 m0, s65
    s_add_u32 s63, s60, 0
    buffer_load_dwordx4 v4, s[28:31], s63 offen offset:0 lds
    s_add_u32 s63, s60, 20480
    buffer_load_dwordx4 v4, s[28:31], s63 offen offset:1024 lds
    s_add_u32 s65, s66, 24576
    s_mov_b32 m0, s65
    s_add_u32 s63, s60, 896
    buffer_load_dwordx4 v4, s[28:31], s63 offen offset:0 lds
    s_add_u32 s63, s60, 21376
    buffer_load_dwordx4 v4, s[28:31], s63 offen offset:1024 lds
    s_add_u32 s65, s66, 32768
    s_mov_b32 m0, s65
    s_add_u32 s63, s60, 1792
    buffer_load_dwordx4 v4, s[28:31], s63 offen offset:0 lds
    s_add_u32 s63, s60, 22272
    buffer_load_dwordx4 v4, s[28:31], s63 offen offset:1024 lds
    s_add_u32 s59, s59, 128
    s_add_u32 s60, s60, 172032
    s_add_u32 s62, s62, 40960
    s_cmp_eq_u32 s62, 122880
    s_cselect_b32 s62, 0, s62
    buffer_load_dword v140, v6, s[76:79], s84 offen
    s_cmp_lt_u32 s82, 6
    s_cselect_b32 s65, s85, 0
    s_add_u32 s84, s84, s65
    s_add_u32 s82, s82, 1
    s_mov_b32 s61, 0
LL_loopA:
    s_waitcnt vmcnt(12)
    s_barrier
    s_lshl_b32 s65, s54, 12
    s_add_u32 s65, s65, s62
    s_mov_b32 m0, s65
    s_mov_b32 s63, s59
    buffer_load_dwordx4 v2, s[24:27], s63 offen offset:0 lds
    s_add_u32 s63, s59, 6144
    buffer_load_dwordx4 v3, s[24:27], s63 offen offset:1024 lds
    s_add_u32 s63, s59, 12288
    buffer_load_dwordx4 v2, s[24:27], s63 offen offset:2048 lds
    s_add_u32 s63, s59, 18432
    buffer_load_dwordx4 v3, s[24:27], s63 offen offset:3072 lds
    s_lshl_b32 s66, s54, 11
    s_add_u32 s66, s66, s62
    s_add_u32 s65, s66, 16384
    s_mov_b32 m0, s65
    s_add_u32 s63, s60, 0
    buffer_load_dwordx4 v4, s[28:31], s63 offen offset:0 lds
    s_add_u32 s63, s60, 20480
    buffer_load_dwordx4 v4, s[28:31], s63 offen offset:1024 lds
    s_add_u32 s65, s66, 24576
    s_mov_b32 m0, s65
    s_add_u32 s63, s60, 896
    buffer_load_dwordx4 v4, s[28:31], s63 offen offset:0 lds
    s_add_u32 s63, s60, 21376
    buffer_load_dwordx4 v4, s[28:31], s63 offen offset:1024 lds
    s_add_u32 s65, s66, 32768
    s_mov_b32 m0, s65
    s_add_u32 s63, s60, 1792
    buffer_load_dwordx4 v4, s[28:31], s63 offen offset:0 lds
    s_add_u32 s63, s60, 22272
    buffer_load_dwordx4 v4, s[28:31], s63 offen offset:1024 lds
    s_add_u32 s59, s59, 128
    s_add_u32 s60, s60, 172032
    s_add_u32 s62, s62, 40960
    s_cmp_eq_u32 s62, 122880
    s_cselect_b32 s62, 0, s62
    buffer_load_dword v140, v6, s[76:79], s84 offen
    s_cmp_lt_u32 s82, 6
    s_cselect_b32 s65, s85, 0
    s_add_u32 s84, s84, s65
    s_add_u32 s82, s82, 1
    s_add_u32 s61, s61, 1
    s_cmp_lt_u32 s61, 4
    s_cbranch_scc1 LL_loopA
    s_waitcnt vmcnt(12)
    s_branch LL_tail
LL_B:
LL_proB:
    s_lshl_b32 s65, s54, 12
    s_add_u32 s65, s65, s62
    s_mov_b32 m0, s65
    s_mov_b32 s63, s59
    buffer_load_dwordx4 v2, s[24:27], s63 offen offset:0 lds
    s_add_u32 s63, s59, 6144
    buffer_load_dwordx4 v3, s[24:27], s63 offen offset:1024 lds
    s_add_u32 s63, s59, 12288
    buffer_load_dwordx4 v2, s[24:27], s63 offen offset:2048 lds
    s_add_u32 s63, s59, 18432
    buffer_load_dwordx4 v3, s[24:27], s63 offen offset:3072 lds
    s_lshl_b32 s66, s54, 13
    s_add_u32 s66, s66, s62
    s_add_u32 s65, s66, 16384
    s_mov_b32 m0, s65
    s_add_u32 s63, s60, 0
    buffer_load_dwordx4 v4, s[28:31], s63 offen offset:0 lds
    s_add_u32 s63, s60, 4352
    buffer_load_dwordx4 v5, s[28:31], s63 offen offset:1024 lds
    s_add_u32 s63, s60, 8704
    buffer_load_dwordx4 v4, s[28:31], s63 offen offset:2048 lds
    s_add_u32 s63, s60, 13056
    buffer_load_dwordx4 v5, s[28:31], s63 offen offset:3072 lds
    s_add_u32 s65, s66, 20480
    s_mov_b32 m0, s65
    s_add_u32 s63, s60, 21504
    buffer_load_dwordx4 v4, s[28:31], s63 offen offset:0 lds
    s_add_u32 s63, s60, 25856
    buffer_load_dwordx4 v5, s[28:31], s63 offen offset:1024 lds
    s_add_u32 s63, s60, 30208
    buffer_load_dwordx4 v4, s[28:31], s63 offen offset:2048 lds
    s_add_u32 s63, s60, 34560
    buffer_load_dwordx4 v5, s[28:31], s63 offen offset:3072 lds
    s_add_u32 s59, s59, 128
    s_add_u32 s60, s60, 172032
    s_add_u32 s62, s62, 49152
    s_cmp_eq_u32 s62, 147456
    s_cselect_b32 s62, 0, s62
    s_add_u32 s61, s61, 1
    s_cmp_lt_u32 s61, 2
    s_cbranch_scc1 LL_proB
    s_cmp_eq_u32 s54, 0
    s_cselect_b32 s76, s24, s28
    s_cselect_b32 s77, s25, s29
    s_cselect_b32 s78, s26, s30
    s_mov_b32 s79, 0x20000
    buffer_load_dword v140, v6, s[76:79], s84 offen
    s_cmp_lt_u32 s82, 6
    s_cselect_b32 s65, s85, 0
    s_add_u32 s84, s84, s65
    s_add_u32 s82, s82, 1
    s_waitcnt vmcnt(13)
    s_barrier
    s_lshl_b32 s65, s54, 12
    s_add_u32 s65, s65, s62
    s_mov_b32 m0, s65
    s_mov_b32 s63, s59
    buffer_load_dwordx4 v2, s[24:27], s63 offen offset:0 lds
    s_add_u32 s63, s59, 6144
    buffer_load_dwordx4 v3, s[24:27], s63 offen offset:1024 lds
    s_add_u32 s63, s59, 12288
    buffer_load_dwordx4 v2, s[24:27], s63 offen offset:2048 lds
    s_add_u32 s63, s59, 18432
    buffer_load_dwordx4 v3, s[24:27], s63 offen offset:3072 lds
    s_lshl_b32 s66, s54, 13
    s_add_u32 s66, s66, s62
    s_add_u32 s65, s66, 16384
    s_mov_b32 m0, s65
    s_add_u32 s63, s60, 0
    buffer_load_dwordx4 v4, s[28:31], s63 offen offset:0 lds
    s_add_u32 s63, s60, 4352
    buffer_load_dwordx4 v5, s[28:31], s63 offen offset:1024 lds
    s_add_u32 s63, s60, 8704
    buffer_load_dwordx4 v4, s[28:31], s63 offen offset:2048 lds
    s_add_u32 s63, s60, 13056
    buffer_load_dwordx4 v5, s[28:31], s63 offen offset:3072 lds
    s_add_u32 s65, s66, 20480
    s_mov_b32 m0, s65
    s_add_u32 s63, s60, 21504
    buffer_load_dwordx4 v4, s[28:31], s63 offen offset:0 lds
    s_add_u32 s63, s60, 25856
    buffer_load_dwordx4 v5, s[28:31], s63 offen offset:1024 lds
    s_add_u32 s63, s60, 30208
    buffer_load_dwordx4 v4, s[28:31], s63 offen offset:2048 lds
    s_add_u32 s63, s60, 34560
    buffer_load_dwordx4 v5, s[28:31], s63 offen offset:3072 lds
    s_add_u32 s59, s59, 128
    s_add_u32 s60, s60, 172032
    s_add_u32 s62, s62, 49152
    s_cmp_eq_u32 s62, 147456
    s_cselect_b32 s62, 0, s62
    buffer_load_dword v140, v6, s[76:79], s84 offen
    s_cmp_lt_u32 s82, 6
    s_cselect_b32 s65, s85, 0
    s_add_u32 s84, s84, s65
    s_add_u32 s82, s82, 1
    s_mov_b32 s61, 0
LL_loopB:
    s_waitcnt vmcnt(14)
    s_barrier
    s_lshl_b32 s65, s54, 12
    s_add_u32 s65, s65, s62
    s_mov_b32 m0, s65
    s_mov_b32 s63, s59
    buffer_load_dwordx4 v2, s[24:27], s63 offen offset:0 lds
    s_add_u32 s63, s59, 6144
    buffer_load_dwordx4 v3, s[24:27], s63 offen offset:1024 lds
    s_add_u32 s63, s59, 12288
    buffer_load_dwordx4 v2, s[24:27], s63 offen offset:2048 lds
    s_add_u32 s63, s59, 18432
    buffer_load_dwordx4 v3, s[24:27], s63 offen offset:3072 lds
    s_lshl_b32 s66, s54, 13
    s_add_u32 s66, s66, s62
    s_add_u32 s65, s66, 16384
    s_mov_b32 m0, s65
    s_add_u32 s63, s60, 0
    buffer_load_dwordx4 v4, s[28:31], s63 offen offset:0 lds
    s_add_u32 s63, s60, 4352
    buffer_load_dwordx4 v5, s[28:31], s63 offen offset:1024 lds
    s_add_u32 s63, s60, 8704
    buffer_load_dwordx4 v4, s[28:31], s63 offen offset:2048 lds
    s_add_u32 s63, s60, 13056
    buffer_load_dwordx4 v5, s[28:31], s63 offen offset:3072 lds
    s_add_u32 s65, s66, 20480
    s_mov_b32 m0, s65
    s_add_u32 s63, s60, 21504
    buffer_load_dwordx4 v4, s[28:31], s63 offen offset:0 lds
    s_add_u32 s63, s60, 25856
    buffer_load_dwordx4 v5, s[28:31], s63 offen offset:1024 lds
    s_add_u32 s63, s60, 30208
    buffer_load_dwordx4 v4, s[28:31], s63 offen offset:2048 lds
    s_add_u32 s63, s60, 34560
    buffer_load_dwordx4 v5, s[28:31], s63 offen offset:3072 lds
    s_add_u32 s59, s59, 128
    s_add_u32 s60, s60, 172032
    s_add_u32 s62, s62, 49152
    s_cmp_eq_u32 s62, 147456
    s_cselect_b32 s62, 0, s62
    buffer_load_dword v140, v6, s[76:79], s84 offen
    s_cmp_lt_u32 s82, 6
    s_cselect_b32 s65, s85, 0
    s_add_u32 s84, s84, s65
    s_add_u32 s82, s82, 1
    s_add_u32 s61, s61, 1
    s_cmp_lt_u32 s61, 4
    s_cbranch_scc1 LL_loopB
    s_waitcnt vmcnt(14)
LL_tail:
    s_barrier
    s_mov_b32 s32, s22
    s_mov_b32 s33, s23
    s_mov_b32 s34, 0x1000000
    s_mov_b32 s35, 0x20000
    s_mov_b32 s44, s20
    s_mov_b32 s45, s21
    s_mov_b32 s46, 0x100
    s_mov_b32 s47, 0x20000
    s_mov_b32 s48, s16
    s_mov_b32 s49, s17
    s_mov_b32 s50, 0x380
    s_mov_b32 s51, 0x20000
    s_cmp_ge_u32 s54, 2
    s_cselect_b32 s36, s14, s8
    s_cselect_b32 s37, s15, s9
    s_mov_b32 s38, 0x62000
    s_mov_b32 s39, 0x20000
    s_cmp_eq_u32 s54, 3
    s_cselect_b32 s64, 1, 0
    s_cmp_lt_u32 s57, 4
    s_cselect_b32 s64, s64, 0
    s_mul_i32 s65, s53, 98
    s_and_b32 s66, s54, 1
    s_lshl_b32 s66, s66, 6
    s_add_u32 s65, s65, s66
    s_lshl_b32 s65, s65, 7
    v_lshlrev_b32 v10, 7, v0
    buffer_load_dword v9, v10, s[36:39], s65 offen
    v_lshlrev_b32 v11, 7, v0
    s_cmp_eq_u32 s54, 0
    s_cbranch_scc0 LL_ft1
    s_and_b32 s65, s53, 1
    s_lshl_b32 s66, s52, 1
    s_add_u32 s65, s65, s66
    s_lshr_b32 s66, s53, 1
    v_add_u32 v12, 2, v0
    v_mul_u32_u24 v13, 43, v12
    v_lshrrev_b32 v13, 7, v13
    v_mul_u32_u24 v14, 3, v13
    v_sub_u32 v14, v12, v14
    v_add_u32 v14, s66, v14
    v_subrev_u32 v14, 2, v14
    v_max_i32 v14, 0, v14
    v_min_i32 v14, 15, v14
    v_lshlrev_b32 v13, 4, v13
    v_add_u32 v13, s65, v13
    v_mul_u32_u24 v13, 43, v13
    v_lshrrev_b32 v13, 8, v13
    v_min_u32 v13, 7, v13
    v_lshl_add_u32 v11, v13, 4, v14
    v_lshlrev_b32 v11, 7, v11
    s_mov_b32 s67, 0xd10000
    s_mov_b64 exec, 0x7f
    s_branch LL_ft4
LL_ft1:
    s_cmp_eq_u32 s54, 1
    s_cbranch_scc0 LL_ft2
    s_lshl_b32 s67, s57, 12
    s_add_u32 s67, s67, 0xd40000
    s_mov_b64 exec, 0xffffffff
    s_branch LL_ft4
LL_ft2:
    s_lshl_b32 s65, s52, 2
    s_and_b32 s66, s53, 3
    s_add_u32 s65, s65, s66
    s_cmp_eq_u32 s54, 2
    s_cbranch_scc0 LL_ft3
    s_lshr_b32 s67, s65, 1
    s_lshl_b32 s67, s67, 12
    s_add_u32 s67, s67, 0xd18000
    s_mov_b64 exec, 0xffff
    s_branch LL_ft4
LL_ft3:
    s_lshl_b32 s67, s65, 11
    s_add_u32 s67, s67, 0xd50000
    s_lshl_b32 s66, s65, 9
    s_add_u32 s66, s66, 0xd27800
    v_cmp_lt_u32 vcc, 15, v0
    v_add_u32 v12, s66, v11
    v_add_u32 v11, s67, v11
    s_mov_b32 s67, 0
    v_cndmask_b32 v11, v11, v12, vcc
    s_mov_b64 exec, 0xfffff
LL_ft4:
    buffer_load_dword v141, v11, s[32:35], s67 offen sc1
    s_mov_b64 exec, -1
    v_lshlrev_b32 v11, 4, v0
    buffer_load_dword v142, v11, s[48:51], 0 offen
    s_waitcnt vmcnt(4)
    s_barrier
    v_lshlrev_b32 v10, 2, v0
    buffer_load_dword v9, v10, s[44:47], 0 offen sc1
    s_cmp_eq_u32 s64, 1
    s_cbranch_scc0 LL_nogl
    s_lshl_b32 s65, s56, 3
    s_lshl_b32 s66, s55, 2
    s_add_u32 s65, s65, s66
    s_add_u32 s3, s65, s57
    v_and_b32 v6, 15, v0
    v_lshrrev_b32 v7, 4, v0
    v_lshlrev_b32 v7, 4, v7
    v_mul_u32_u24 v8, 896, v6
    v_add_u32 v8, v8, v7
    s_mul_i32 s66, s3, 14336
    buffer_load_dwordx4 v[16:19], v8, s[24:27], s66 offen offset:0
    buffer_load_dwordx4 v[72:75], v7, s[48:51], 0 offen offset:0
    buffer_load_dwordx4 v[20:23], v8, s[24:27], s66 offen offset:64
    buffer_load_dwordx4 v[76:79], v7, s[48:51], 0 offen offset:64
    buffer_load_dwordx4 v[24:27], v8, s[24:27], s66 offen offset:128
    buffer_load_dwordx4 v[80:83], v7, s[48:51], 0 offen offset:128
    buffer_load_dwordx4 v[28:31], v8, s[24:27], s66 offen offset:192
    buffer_load_dwordx4 v[84:87], v7, s[48:51], 0 offen offset:192
    buffer_load_dwordx4 v[32:35], v8, s[24:27], s66 offen offset:256
    buffer_load_dwordx4 v[88:91], v7, s[48:51], 0 offen offset:256
    buffer_load_dwordx4 v[36:39], v8, s[24:27], s66 offen offset:320
    buffer_load_dwordx4 v[92:95], v7, s[48:51], 0 offen offset:320
    buffer_load_dwordx4 v[40:43], v8, s[24:27], s66 offen offset:384
    buffer_load_dwordx4 v[96:99], v7, s[48:51], 0 offen offset:384
    buffer_load_dwordx4 v[44:47], v8, s[24:27], s66 offen offset:448
    buffer_load_dwordx4 v[100:103], v7, s[48:51], 0 offen offset:448
    buffer_load_dwordx4 v[48:51], v8, s[24:27], s66 offen offset:512
    buffer_load_dwordx4 v[104:107], v7, s[48:51], 0 offen offset:512
    buffer_load_dwordx4 v[52:55], v8, s[24:27], s66 offen offset:576
    buffer_load_dwordx4 v[108:111], v7, s[48:51], 0 offen offset:576
    buffer_load_dwordx4 v[56:59], v8, s[24:27], s66 offen offset:640
    buffer_load_dwordx4 v[112:115], v7, s[48:51], 0 offen offset:640
    buffer_load_dwordx4 v[60:63], v8, s[24:27], s66 offen offset:704
    buffer_load_dwordx4 v[116:119], v7, s[48:51], 0 offen offset:704
    buffer_load_dwordx4 v[64:67], v8, s[24:27], s66 offen offset:768
    buffer_load_dwordx4 v[120:123], v7, s[48:51], 0 offen offset:768
    buffer_load_dwordx4 v[68:71], v8, s[24:27], s66 offen offset:832
    buffer_load_dwordx4 v[124:127], v7, s[48:51], 0 offen offset:832
LL_nogl:
    s_barrier
    s_cmp_eq_u32 s64, 1
    s_cbranch_scc0 LL_nogc
    s_waitcnt vmcnt(26)
    v_mfma_f32_16x16x32_bf16 v[128:131], v[72:75], v[16:19], 0
    s_waitcnt vmcnt(24)
    v_mfma_f32_16x16x32_bf16 v[128:131], v[76:79], v[20:23], v[128:131]
    s_waitcnt vmcnt(22)
    v_mfma_f32_16x16x32_bf16 v[128:131], v[80:83], v[24:27], v[128:131]
    s_waitcnt vmcnt(20)
    v_mfma_f32_16x16x32_bf16 v[128:131], v[84:87], v[28:31], v[128:131]
    s_waitcnt vmcnt(18)
    v_mfma_f32_16x16x32_bf16 v[128:131], v[88:91], v[32:35], v[128:131]
    s_waitcnt vmcnt(16)
    v_mfma_f32_16x16x32_bf16 v[128:131], v[92:95], v[36:39], v[128:131]
    s_waitcnt vmcnt(14)
    v_mfma_f32_16x16x32_bf16 v[128:131], v[96:99], v[40:43], v[128:131]
    s_waitcnt vmcnt(12)
    v_mfma_f32_16x16x32_bf16 v[128:131], v[100:103], v[44:47], v[128:131]
    s_waitcnt vmcnt(10)
    v_mfma_f32_16x16x32_bf16 v[128:131], v[104:107], v[48:51], v[128:131]
    s_waitcnt vmcnt(8)
    v_mfma_f32_16x16x32_bf16 v[128:131], v[108:111], v[52:55], v[128:131]
    s_waitcnt vmcnt(6)
    v_mfma_f32_16x16x32_bf16 v[128:131], v[112:115], v[56:59], v[128:131]
    s_waitcnt vmcnt(4)
    v_mfma_f32_16x16x32_bf16 v[128:131], v[116:119], v[60:63], v[128:131]
    s_waitcnt vmcnt(2)
    v_mfma_f32_16x16x32_bf16 v[128:131], v[120:123], v[64:67], v[128:131]
    s_waitcnt vmcnt(0)
    v_mfma_f32_16x16x32_bf16 v[128:131], v[124:127], v[68:71], v[128:131]
    s_nop 7
    v_mul_f32 v8, 0xbfb8aa3b, v128
    v_exp_f32 v8, v8
    s_nop 0
    v_add_f32 v8, 1.0, v8
    v_rcp_f32 v8, v8
    s_lshl_b32 s66, s3, 6
    s_add_u32 s67, s66, 0xd00000
    v_lshlrev_b32 v7, 2, v6
    s_mov_b64 exec, 0xffff
    buffer_store_dword v8, v7, s[32:35], s67 offen sc1
    s_mov_b64 exec, -1
LL_nogc:
    v_lshrrev_b32 v14, 3, v0
    v_and_b32 v12, 7, v0
    v_bfe_u32 v13, v0, 4, 1
    v_lshlrev_b32 v13, 2, v13
    v_xor_b32 v12, v12, v13
    v_mul_u32_u24 v14, 896, v14
    v_lshl_add_u32 v14, v12, 4, v14
    s_and_b32 s65, s54, 1
    s_mul_i32 s65, s65, 28
    s_lshr_b32 s66, s54, 1
    s_mul_i32 s66, s66, 57344
    s_lshl_b32 s67, s65, 10
    s_add_u32 s10, s66, s67
    s_mul_i32 s67, s65, 7168
    s_lshr_b32 s66, s53, 2
    s_lshl_b32 s66, s66, 7
    s_add_u32 s11, s67, s66
    s_and_b32 s65, s54, 1
    s_lshl_b32 s66, s57, 1
    s_add_u32 s71, s65, s66
    s_lshr_b32 s65, s54, 1
    s_lshl_b32 s65, s65, 1
    s_lshl_b32 s66, s56, 2
    s_add_u32 s72, s65, s66
    s_barrier
    s_waitcnt vmcnt(0)
    v_readfirstlane_b32 s58, v9
    s_mov_b32 s74, 0
    s_nop 2
    s_cmp_lg_u32 s58, 0
    s_cbranch_scc1 L_nonce_14_x
L_nonce_14:
    v_lshlrev_b32 v10, 2, v0
    buffer_load_dword v9, v10, s[44:47], 0 offen sc1
    s_waitcnt vmcnt(0)
    v_readfirstlane_b32 s58, v9
    s_add_u32 s74, s74, 1
    s_cmp_gt_u32 s74, 400000
    s_cbranch_scc1 L_nonce_14_x
    s_cmp_eq_u32 s58, 0
    s_cbranch_scc1 L_nonce_14
L_nonce_14_x:
    s_cmp_eq_u32 s64, 1
    s_cbranch_scc0 LL_nogp
    s_lshl_b32 s66, s3, 7
    s_add_u32 s66, s66, 0xd28000
    v_mov_b32 v12, 0
    v_mov_b32 v13, s58
    s_mov_b64 exec, 1
    buffer_store_dword v13, v12, s[32:35], s66 offen sc1
    s_mov_b64 exec, -1
LL_nogp:
    s_cmp_ge_u32 s53, 28
    s_cbranch_scc1 LL_nowo1
    s_mov_b32 s16, s10
    s_mov_b32 s17, s11
    s_add_u32 s10, s10, 16384
    s_add_u32 s11, s11, 114688
    s_mov_b32 m0, s10
    s_add_u32 s10, s10, 4096
    buffer_load_dwordx4 v14, s[36:39], s11 offen offset:0 lds
    s_add_u32 s11, s11, 6144
    buffer_load_dwordx4 v14, s[36:39], s11 offen offset:1024 lds
    s_add_u32 s11, s11, 6144
    buffer_load_dwordx4 v14, s[36:39], s11 offen offset:2048 lds
    s_add_u32 s11, s11, 6144
    buffer_load_dwordx4 v14, s[36:39], s11 offen offset:3072 lds
    s_add_u32 s11, s11, 10240
    s_mov_b32 m0, s10
    s_add_u32 s10, s10, 4096
    buffer_load_dwordx4 v14, s[36:39], s11 offen offset:0 lds
    s_add_u32 s11, s11, 6144
    buffer_load_dwordx4 v14, s[36:39], s11 offen offset:1024 lds
    s_add_u32 s11, s11, 6144
    buffer_load_dwordx4 v14, s[36:39], s11 offen offset:2048 lds
    s_add_u32 s11, s11, 6144
    buffer_load_dwordx4 v14, s[36:39], s11 offen offset:3072 lds
    s_add_u32 s11, s11, 10240
    s_mov_b32 m0, s10
    s_add_u32 s10, s10, 4096
    buffer_load_dwordx4 v14, s[36:39], s11 offen offset:0 lds
    s_add_u32 s11, s11, 6144
    buffer_load_dwordx4 v14, s[36:39], s11 offen offset:1024 lds
    s_add_u32 s11, s11, 6144
    buffer_load_dwordx4 v14, s[36:39], s11 offen offset:2048 lds
    s_add_u32 s11, s11, 6144
    buffer_load_dwordx4 v14, s[36:39], s11 offen offset:3072 lds
    s_add_u32 s11, s11, 10240
LL_nowo1:
    s_barrier
    s_cmp_eq_u32 s55, 0
    s_cbranch_scc0 LL_a1
    s_lshl_b32 s65, s54, 12
    v_add_u32 v11, s65, v1
    ds_read_b128 v[20:23], v11 offset:0
    ds_read_b128 v[24:27], v11 offset:1024
    ds_read_b128 v[28:31], v11 offset:2048
    ds_read_b128 v[32:35], v11 offset:3072
    v_lshlrev_b32 v12, 7, v0
    s_lshl_b32 s65, s71, 11
    s_add_u32 s75, s65, 0xd40000
    buffer_load_dword v15, v12, s[32:35], s75 offen sc1
    s_waitcnt lgkmcnt(0)
LL_a1:
    s_barrier
    s_cmp_eq_u32 s55, 0
    s_cbranch_scc0 LL_a2
    s_waitcnt vmcnt(0)
    v_cmp_eq_u32 vcc, s58, v15
    s_nop 3
    s_and_b32 s70, vcc_lo, 0xffff
    s_cmp_eq_u32 s70, 0xffff
    s_cbranch_scc1 LL_fpok
    s_mov_b32 s74, 0
L_poll_15:
    buffer_load_dword v15, v12, s[32:35], s75 offen sc1
    s_waitcnt vmcnt(0)
    v_cmp_eq_u32 vcc, s58, v15
    s_add_u32 s74, s74, 1
    s_cmp_gt_u32 s74, 400000
    s_cbranch_scc1 L_polled_16
    s_and_b32 s70, vcc_lo, 0xffff
    s_cmp_eq_u32 s70, 0xffff
    s_cbranch_scc1 L_polled_16
    s_sleep 2
    s_branch L_poll_15
L_polled_16:
LL_fpok:
    s_lshl_b32 s65, s71, 12
    s_add_u32 s65, s65, 0xc00000
    v_lshlrev_b32 v13, 2, v0
    buffer_load_dword v40, v13, s[32:35], s65 offen offset:0 sc1
    buffer_load_dword v41, v13, s[32:35], s65 offen offset:256 sc1
    buffer_load_dword v42, v13, s[32:35], s65 offen offset:512 sc1
    buffer_load_dword v43, v13, s[32:35], s65 offen offset:768 sc1
    buffer_load_dword v44, v13, s[32:35], s65 offen offset:1024 sc1
    buffer_load_dword v45, v13, s[32:35], s65 offen offset:1280 sc1
    buffer_load_dword v46, v13, s[32:35], s65 offen offset:1536 sc1
    buffer_load_dword v47, v13, s[32:35], s65 offen offset:1792 sc1
    buffer_load_dword v48, v13, s[32:35], s65 offen offset:2048 sc1
    buffer_load_dword v49, v13, s[32:35], s65 offen offset:2304 sc1
    buffer_load_dword v50, v13, s[32:35], s65 offen offset:2560 sc1
    buffer_load_dword v51, v13, s[32:35], s65 offen offset:2816 sc1
    buffer_load_dword v52, v13, s[32:35], s65 offen offset:3072 sc1
    buffer_load_dword v53, v13, s[32:35], s65 offen offset:3328 sc1
    buffer_load_dword v54, v13, s[32:35], s65 offen offset:3584 sc1
    buffer_load_dword v55, v13, s[32:35], s65 offen offset:3840 sc1
LL_a2:
    s_barrier
    s_cmp_eq_u32 s55, 0
    s_cbranch_scc0 LL_a3
    s_waitcnt vmcnt(0)
    s_setprio 2
    v_cvt_pk_bf16_f32 v40, v40, v41
    v_cvt_pk_bf16_f32 v41, v42, v43
    v_cvt_pk_bf16_f32 v42, v44, v45
    v_cvt_pk_bf16_f32 v43, v46, v47
    v_cvt_pk_bf16_f32 v44, v48, v49
    v_cvt_pk_bf16_f32 v45, v50, v51
    v_cvt_pk_bf16_f32 v46, v52, v53
    v_cvt_pk_bf16_f32 v47, v54, v55
    v_cmp_gt_u32 vcc, 32, v0
    s_mov_b32 s66, 0x358637bd
    v_mfma_f32_32x32x16_bf16 v[64:79], v[40:43], v[20:23], 0
    v_mfma_f32_32x32x16_bf16 v[64:79], v[44:47], v[24:27], v[64:79]
    v_mfma_f32_32x32x16_bf16 v[80:95], v[40:43], v[28:31], 0
    v_mfma_f32_32x32x16_bf16 v[80:95], v[44:47], v[32:35], v[80:95]
    s_nop 11
    v_mov_b32 v6, v76
    v_mov_b32 v7, v76
    s_nop 1
    v_permlane32_swap_b32 v6, v7
    v_add_f32 v7, s66, v7
    v_rcp_f32 v7, v7
    s_nop 0
    v_mov_b32 v6, v7
    v_pk_mul_f32 v[64:65], v[64:65], v[6:7]
    v_pk_mul_f32 v[66:67], v[66:67], v[6:7]
    v_pk_mul_f32 v[68:69], v[68:69], v[6:7]
    v_pk_mul_f32 v[70:71], v[70:71], v[6:7]
    v_pk_mul_f32 v[72:73], v[72:73], v[6:7]
    v_pk_mul_f32 v[74:75], v[74:75], v[6:7]
    v_pk_mul_f32 v[76:77], v[76:77], v[6:7]
    v_pk_mul_f32 v[78:79], v[78:79], v[6:7]
    v_cvt_pk_bf16_f32 v64, v64, v65
    v_cvt_pk_bf16_f32 v65, v66, v67
    v_cvt_pk_bf16_f32 v66, v68, v69
    v_cvt_pk_bf16_f32 v67, v70, v71
    v_cvt_pk_bf16_f32 v68, v72, v73
    v_cvt_pk_bf16_f32 v69, v74, v75
    v_cvt_pk_bf16_f32 v70, v76, v77
    v_cvt_pk_bf16_f32 v71, v78, v79
    v_cndmask_b32 v70, 0, v70, vcc
    v_cndmask_b32 v71, 0, v71, vcc
    s_add_u32 s65, s72, 0
    s_lshl_b32 s65, s65, 4
    s_add_u32 s65, s65, s71
    s_lshl_b32 s65, s65, 11
    s_add_u32 s65, s65, 0xa00000
    buffer_store_dwordx4 v[64:67], v1, s[32:35], s65 offen sc1
    buffer_store_dwordx4 v[68:71], v1, s[32:35], s65 offen offset:1024 sc1
    v_mov_b32 v6, v92
    v_mov_b32 v7, v92
    s_nop 1
    v_permlane32_swap_b32 v6, v7
    v_add_f32 v7, s66, v7
    v_rcp_f32 v7, v7
    s_nop 0
    v_mov_b32 v6, v7
    v_pk_mul_f32 v[80:81], v[80:81], v[6:7]
    v_pk_mul_f32 v[82:83], v[82:83], v[6:7]
    v_pk_mul_f32 v[84:85], v[84:85], v[6:7]
    v_pk_mul_f32 v[86:87], v[86:87], v[6:7]
    v_pk_mul_f32 v[88:89], v[88:89], v[6:7]
    v_pk_mul_f32 v[90:91], v[90:91], v[6:7]
    v_pk_mul_f32 v[92:93], v[92:93], v[6:7]
    v_pk_mul_f32 v[94:95], v[94:95], v[6:7]
    v_cvt_pk_bf16_f32 v80, v80, v81
    v_cvt_pk_bf16_f32 v81, v82, v83
    v_cvt_pk_bf16_f32 v82, v84, v85
    v_cvt_pk_bf16_f32 v83, v86, v87
    v_cvt_pk_bf16_f32 v84, v88, v89
    v_cvt_pk_bf16_f32 v85, v90, v91
    v_cvt_pk_bf16_f32 v86, v92, v93
    v_cvt_pk_bf16_f32 v87, v94, v95
    v_cndmask_b32 v86, 0, v86, vcc
    v_cndmask_b32 v87, 0, v87, vcc
    s_add_u32 s65, s72, 1
    s_lshl_b32 s65, s65, 4
    s_add_u32 s65, s65, s71
    s_lshl_b32 s65, s65, 11
    s_add_u32 s65, s65, 0xa00000
    buffer_store_dwordx4 v[80:83], v1, s[32:35], s65 offen sc1
    buffer_store_dwordx4 v[84:87], v1, s[32:35], s65 offen offset:1024 sc1
    s_lshr_b32 s65, s72, 1
    s_lshl_b32 s65, s65, 4
    s_add_u32 s65, s65, s71
    s_lshl_b32 s65, s65, 7
    s_add_u32 s75, s65, 0xd50000
    s_setprio 0
LL_a3:
    s_cmp_ge_u32 s53, 28
    s_cbranch_scc1 LL_no16
    s_mov_b32 s10, s16
    s_mov_b32 s11, s17
    s_mov_b32 m0, s10
    s_add_u32 s10, s10, 4096
    buffer_load_dwordx4 v14, s[36:39], s11 offen offset:0 lds
    s_add_u32 s11, s11, 6144
    buffer_load_dwordx4 v14, s[36:39], s11 offen offset:1024 lds
    s_add_u32 s11, s11, 6144
    buffer_load_dwordx4 v14, s[36:39], s11 offen offset:2048 lds
    s_add_u32 s11, s11, 6144
    buffer_load_dwordx4 v14, s[36:39], s11 offen offset:3072 lds
    s_add_u32 s11, s11, 10240
    s_mov_b32 m0, s10
    s_add_u32 s10, s10, 4096
    buffer_load_dwordx4 v14, s[36:39], s11 offen offset:0 lds
    s_add_u32 s11, s11, 6144
    buffer_load_dwordx4 v14, s[36:39], s11 offen offset:1024 lds
    s_add_u32 s11, s11, 6144
    buffer_load_dwordx4 v14, s[36:39], s11 offen offset:2048 lds
    s_add_u32 s11, s11, 6144
    buffer_load_dwordx4 v14, s[36:39], s11 offen offset:3072 lds
    s_add_u32 s11, s11, 10240
    s_cmp_eq_u32 s55, 0
    s_cbranch_scc0 LL_a7
    s_waitcnt vmcnt(8)
    v_mov_b32 v12, 0
    v_mov_b32 v13, s58
    s_mov_b64 exec, 1
    buffer_store_dword v13, v12, s[32:35], s75 offen sc1
    s_mov_b64 exec, -1
LL_a7:
    s_mov_b32 m0, s10
    s_add_u32 s10, s10, 4096
    buffer_load_dwordx4 v14, s[36:39], s11 offen offset:0 lds
    s_add_u32 s11, s11, 6144
    buffer_load_dwordx4 v14, s[36:39], s11 offen offset:1024 lds
    s_add_u32 s11, s11, 6144
    buffer_load_dwordx4 v14, s[36:39], s11 offen offset:2048 lds
    s_add_u32 s11, s11, 6144
    buffer_load_dwordx4 v14, s[36:39], s11 offen offset:3072 lds
    s_add_u32 s11, s11, 10240
    s_mov_b32 m0, s10
    s_add_u32 s10, s10, 4096
    buffer_load_dwordx4 v14, s[36:39], s11 offen offset:0 lds
    s_add_u32 s11, s11, 6144
    buffer_load_dwordx4 v14, s[36:39], s11 offen offset:1024 lds
    s_add_u32 s11, s11, 6144
    buffer_load_dwordx4 v14, s[36:39], s11 offen offset:2048 lds
    s_add_u32 s11, s11, 6144
    buffer_load_dwordx4 v14, s[36:39], s11 offen offset:3072 lds
    s_add_u32 s11, s11, 10240
    s_branch LL_a6
LL_no16:
    s_cmp_eq_u32 s55, 0
    s_cbranch_scc0 LL_a6
    s_waitcnt vmcnt(0)
    v_mov_b32 v12, 0
    v_mov_b32 v13, s58
    s_mov_b64 exec, 1
    buffer_store_dword v13, v12, s[32:35], s75 offen sc1
    s_mov_b64 exec, -1
LL_a6:
    s_waitcnt vmcnt(0)
LL_nowo:
    s_barrier
    s_endpgm
L_codeend:
.fill 64, 4, 0xBF800000
.section .rodata,"a"
.p2align 6
.amdhsa_kernel gated_mix__linear_attn_block__sliding_block__prompt_kernel
  .amdhsa_next_free_vgpr 256
  .amdhsa_next_free_sgpr 102
  .amdhsa_accum_offset 208
  .amdhsa_group_segment_fixed_size 0
  .amdhsa_kernarg_size 80
  .amdhsa_user_sgpr_count 2
  .amdhsa_user_sgpr_kernarg_segment_ptr 1
  .amdhsa_system_sgpr_workgroup_id_x 1
  .amdhsa_float_denorm_mode_32 3
.end_amdhsa_kernel
```
